```python
import torch

def _softmax(x, axis=-1):
    return torch.softmax(x, dim=axis)
def _gelu(x):
    return torch.nn.functional.gelu(x, approximate="tanh")
def _silu(x):
    return torch.nn.functional.silu(x)
def _sigmoid(x):
    return torch.sigmoid(x)
def _layernorm(x, axis=-1, eps=1e-5):
    m = x.mean(dim=axis, keepdim=True)
    v = x.var(dim=axis, keepdim=True, unbiased=False)
    return (x - m) / torch.sqrt(v + eps)
def _scatter_add(tgt, idx, src, axis=0):
    return tgt.clone().index_add_(axis, idx, src)
def _segment_sum(src, seg, n):
    out = torch.zeros((n,) + src.shape[1:], dtype=src.dtype)
    return out.index_add_(0, seg, src)
def _pad(x, pw):
    flat = tuple(v for pair in reversed(pw) for v in pair)
    return torch.nn.functional.pad(x, flat)

kernel_name = 'concat_heads__linear_attn_block__spectral_gfnet__prompt'

def setup_inputs():

    _w = (lambda a: (lambda t: t.to(torch.bfloat16) if t.is_floating_point() else t)(torch.as_tensor(a)))
    def _A_setup():
        B, S, D = 1, 2048, 512
        return {
            "x": _w((lambda *s: torch.randn(*s, dtype=torch.bfloat16) * 0.05)(B, S, D)),
            "wqkv": _w((lambda *s: torch.randn(*s, dtype=torch.bfloat16) * 0.4)(D, 3 * D)),
            "wo": _w((lambda *s: torch.randn(*s, dtype=torch.bfloat16) * 0.05)(D, D)),
        }
    _A_in = _A_setup()

    def _B_setup():
        B, S, D = 1, 2048, 512
        Df = D // 2 + 1
        return {
            "x": _w((lambda *s: torch.randn(*s, dtype=torch.bfloat16) * 0.05)(B, S, D)),
            "w_r": _w((lambda *s: torch.randn(*s, dtype=torch.bfloat16) * 1.6)(S, Df) * 0.02),
            "w_i": _w((lambda *s: torch.randn(*s, dtype=torch.bfloat16) * 1.6)(S, Df) * 0.02),
        }
    _B_in = _B_setup()

    return {
        "A_x": _A_in["x"],
        "A_wqkv": _A_in["wqkv"],
        "A_wo": _A_in["wo"],
        "B_x": _B_in["x"],
        "B_w_r": _B_in["w_r"],
        "B_w_i": _B_in["w_i"],
    }

def reference(A_x, A_wqkv, A_wo, B_x, B_w_r, B_w_i):
    def _A_ref(x, wqkv, wo):
        B, S, D = x.shape
        H = 32; Dh = D // H
        qkv = (lambda x, *d: x.permute(*d))((x @ wqkv).reshape(B, S, 3, H, Dh), 2, 0, 3, 1, 4)
        q, k, v = qkv[0], qkv[1], qkv[2]
        phi = lambda t: torch.where(t > 0, t + 1, torch.exp(t)) + 1e-6
        pq, pk = phi(q), phi(k)
        kv = torch.einsum("bhsd,bhse->bhde", pk, v)
        z = torch.einsum("bhsd->bhd", pk)
        num = torch.einsum("bhqd,bhde->bhqe", pq, kv)
        den = torch.einsum("bhqd,bhd->bhq", pq, z)[..., None] + 1e-6
        o = num / den
        return (lambda x, *d: x.permute(*d))(o, 0, 2, 1, 3).reshape(B, S, D) @ wo

    def _B_ref(x, w_r, w_i):
        B, S, D = x.shape
        X = (lambda x, axes=(-2,-1): torch.fft.rfft2(x.float(), dim=axes))(x, axes=(-2, -1))
        W = w_r + 1j * w_i
        X = X * W
        y = (lambda x, s, axes=(-2,-1): torch.fft.irfft2(x, s=s, dim=axes).to(torch.bfloat16))(X, (S, D), axes=(-2, -1))
        return y

    a = _A_ref(A_x, A_wqkv, A_wo)
    b = _B_ref(B_x, B_w_r, B_w_i)
    return torch.concatenate([a, b], axis=-1)
```

```asm
; @launch grid=(256,1,1) block=(512,1,1) lds=163840
.amdgcn_target "amdgcn-amd-amdhsa--gfx950"
.text
.globl concat_heads__linear_attn_block__spectral_gfnet__prompt_kernel
.p2align 8
.type concat_heads__linear_attn_block__spectral_gfnet__prompt_kernel,@function
concat_heads__linear_attn_block__spectral_gfnet__prompt_kernel:
    s_cmp_ge_u32 s2, 256
    s_cbranch_scc1 L_END
    s_load_dwordx16 s[4:19], s[0:1], 0
    s_load_dwordx2 s[20:21], s[0:1], 64
    v_lshrrev_b32 v4, 6, v0
    s_lshr_b32 s49, s2, 3
    v_readfirstlane_b32 s3, v4
    v_and_b32 v0, 63, v0
    s_cmp_eq_u32 s3, 0
    s_cbranch_scc0 C_NOPF
    s_mov_b32 exec_lo, -1
    s_mov_b32 exec_hi, 0
    s_getpc_b64 s[60:61]
L_PC:
    s_mul_i32 s62, s49, 768
    v_min_u32 v1, 5, v0
    v_lshlrev_b32 v1, 7, v1
    v_add_u32 v1, s62, v1
    v_min_u32 v1, L_END-L_PC, v1
    global_load_dword v1, v1, s[60:61]
    v_lshlrev_b32 v2, 2, v0
    v_add_u32 v2, 163584, v2
    v_mov_b32 v3, 0
    ds_write_b32 v2, v3
    s_mov_b64 exec, -1
C_NOPF:
    s_and_b32 s48, s2, 7
    v_lshlrev_b32 v7, 4, v0
    s_mov_b32 s30, 0x200000
    s_mov_b32 s31, 0x20000
    s_and_b32 s52, s49, 3
    s_lshl2_add_u32 s50, s48, s52
    s_lshr_b32 s51, s49, 2
    s_lshl1_add_u32 s52, s52, s51
    s_cmp_ge_u32 s3, 4
    s_cbranch_scc1 L_START
    s_lshl_b32 s69, s3, 11
    s_lshl_b32 s58, s3, 19
    s_lshl_b32 s59, s2, 10
    s_add_u32 s58, s58, s59
    s_add_u32 s59, s58, 261120
    s_add_u32 m0, s69, 131072
    s_cmp_ge_u32 s2, 209
    s_cselect_b32 s22, 0, -1
    v_mov_b32 v208, s22
    v_mov_b32 v209, s22
    v_mov_b32 v210, s22
    v_mov_b32 v211, s22
    s_sub_u32 s52, s2, 129
    s_cmp_eq_u32 s3, 3
    s_cselect_b32 s52, s52, -1
    s_lshl_b32 s65, s52, 13
    s_add_u32 s65, s65, 7012352
    s_mov_b32 s26, 10485760
    s_mov_b32 s27, s31
    s_cmp_lt_u32 s52, 82
    s_waitcnt lgkmcnt(0)
    s_mov_b64 s[28:29], s[10:11]
    s_cselect_b32 s23, 1, 0
    s_add_u32 s24, s20, 0
    s_addc_u32 s25, s21, 0
    s_cmp_eq_u32 s23, 1
    s_cbranch_scc1 C_CLR
C_NOCLR:
    buffer_load_dwordx4 v7, s[28:31], s58 offen  lds
    buffer_load_dwordx4 v7, s[28:31], s59 offen offset:1024  lds
    s_barrier
    s_branch C_MAIN
C_CLR:
    buffer_store_dwordx4 v[208:211], v7, s[24:27], s65 offen sc1
    buffer_store_dwordx4 v[208:211], v7, s[24:27], s65 offen offset:1024 sc1
    buffer_store_dwordx4 v[208:211], v7, s[24:27], s65 offen offset:2048 sc1
    buffer_store_dwordx4 v[208:211], v7, s[24:27], s65 offen offset:3072 sc1
    s_bitset1_b32 s65, 12
    buffer_store_dwordx4 v[208:211], v7, s[24:27], s65 offen sc1
    buffer_store_dwordx4 v[208:211], v7, s[24:27], s65 offen offset:1024 sc1
    buffer_store_dwordx4 v[208:211], v7, s[24:27], s65 offen offset:2048 sc1
    buffer_store_dwordx4 v[208:211], v7, s[24:27], s65 offen offset:3072 sc1
    s_branch C_NOCLR
L_START:
    s_sub_u32 s58, s3, 4
    s_add_u32 s52, s52, s48
    s_and_b32 s52, s52, 7
    v_lshrrev_b32 v8, 3, v0
    v_and_b32 v9, 7, v0
    v_and_b32 v10, 6, v8
    v_xor_b32 v9, v9, v10
    v_lshlrev_b32 v9, 4, v9
    v_lshl_add_u32 v5, v8, 10, v9
    v_and_b32 v10, 4, v8
    v_add_u32 v10, v10, v8
    v_mul_u32_u24 v6, 3072, v10
    v_add_u32 v6, v6, v9
    s_lshl2_add_u32 s60, s50, s58
    s_lshl_b32 s60, s60, 14
    s_lshl_b32 s61, s51, 7
    s_mul_i32 s62, s58, 49152
    s_add_u32 s61, s61, s62
    s_addk_i32 s61, 1024
    s_lshl_b32 s62, s58, 11
    s_lshl_b32 s64, s58, 12
    s_mov_b32 s34, 0x180000
    s_mov_b32 s35, s31
    s_mov_b32 s38, 1052672
    s_mov_b32 s39, s31
    s_mov_b32 s42, s38
    s_mov_b32 s43, s31
    s_waitcnt lgkmcnt(0)
    s_mov_b64 s[32:33], s[6:7]
    s_mov_b64 s[28:29], s[4:5]
    s_barrier
    s_mul_i32 s66, s52, 196608
    s_add_u32 m0, s64, 0
    s_add_u32 s66, s66, s61
    buffer_load_dwordx4 v6, s[32:35], s66 offen  lds
    buffer_load_dwordx4 v6, s[32:35], s66 offen offset:1024  lds
    s_add_u32 s66, s66, 10240
    buffer_load_dwordx4 v6, s[32:35], s66 offen offset:2048  lds
    buffer_load_dwordx4 v6, s[32:35], s66 offen offset:3072  lds
    s_lshl_b32 s65, s52, 7
    s_add_u32 m0, s62, 65536
    s_add_u32 s65, s65, s60
    buffer_load_dwordx4 v5, s[28:31], s65 offen  lds
    s_add_u32 s65, s65, 7168
    buffer_load_dwordx4 v5, s[28:31], s65 offen offset:1024  lds
    s_add_u32 s52, s52, 1
    s_and_b32 s52, s52, 7
    s_mov_b64 s[0:1], s[12:13]
    s_mov_b64 s[70:71], s[14:15]
    s_cmp_eq_u32 s58, 0
    s_cbranch_scc0 L_NOSP
    s_mov_b64 s[36:37], s[12:13]
    s_mov_b64 s[40:41], s[14:15]
    s_and_b32 s75, s48, 3
    s_cmp_eq_u32 s48, 4
    s_cselect_b32 s68, 4, s75
    s_and_b32 s56, s49, 7
    s_lshl4_add_u32 s68, s56, s68
    s_lshr_b32 s69, s49, 3
    s_lshl_b32 s22, s69, 9
    s_add_u32 s68, s68, s22
    s_sub_u32 s22, 2048, s68
    s_cmp_ge_u32 s48, 4
    s_cselect_b32 s68, s22, s68
    s_cselect_b32 s59, 0x80000000, 0
    s_movk_i32 s67, 4112
    s_cmovk_i32 s67, -4112
    s_mulk_i32 s68, 514
    v_and_b32 v12, 3, v0
    v_lshlrev_b32 v12, 4, v12
    v_lshrrev_b32 v11, 4, v0
    v_add_u32 v12, v12, v11
    v_mul_i32_i24 v12, s67, v12
    v_add_u32 v12, s68, v12
    v_sub_u32 v11, 1052672, v12
    s_lshr_b32 s23, s59, 22
    s_sub_u32 s22, 512, s23
    s_cmp_eq_u32 s75, 0
    s_cselect_b64 vcc, -1, 0
    s_cselect_b32 s22, s22, s23
    v_cndmask_b32 v11, v11, v12, vcc
    s_mov_b32 exec_hi, 0
    buffer_load_ushort v192, v12, s[36:39], s23 offen
    buffer_load_ushort v193, v12, s[40:43], s23 offen
    buffer_load_ushort v106, v11, s[36:39], s22 offen
    buffer_load_ushort v107, v11, s[40:43], s22 offen
    s_mov_b32 exec_hi, -1
L_NOSP:
    s_mul_i32 s66, s52, 196608
    s_add_u32 m0, s64, 16384
    s_add_u32 s66, s66, s61
    buffer_load_dwordx4 v6, s[32:35], s66 offen  lds
    buffer_load_dwordx4 v6, s[32:35], s66 offen offset:1024  lds
    s_add_u32 s66, s66, 10240
    buffer_load_dwordx4 v6, s[32:35], s66 offen offset:2048  lds
    buffer_load_dwordx4 v6, s[32:35], s66 offen offset:3072  lds
    s_lshl_b32 s65, s52, 7
    s_add_u32 m0, s62, 73728
    s_add_u32 s65, s65, s60
    buffer_load_dwordx4 v5, s[28:31], s65 offen  lds
    s_add_u32 s65, s65, 7168
    buffer_load_dwordx4 v5, s[28:31], s65 offen offset:1024  lds
    s_add_u32 s52, s52, 1
    s_and_b32 s52, s52, 7
    v_lshl_add_u32 v4, v10, 10, v9
    s_mov_b64 s[36:37], s[8:9]
    s_mov_b32 s38, 524288
    s_mov_b32 s39, 0x20000
    s_add_u32 s24, s20, 0
    s_addc_u32 s25, s21, 0
    s_mov_b64 s[40:41], s[16:17]
    s_mov_b64 s[44:45], s[18:19]
    s_mov_b32 s26, 10485760
    s_mov_b32 s27, 0x20000
    s_mov_b32 s42, 4194304
    s_mov_b32 s43, 0x20000
    s_mov_b32 s46, 256
    s_mov_b32 s47, 0x20000
    s_mov_b32 s72, 262144
    s_mov_b32 s74, 4194304
    v_mov_b32 v254, 163584
    v_mov_b32 v255, 1
    v_and_b32 v2, 15, v0
    v_lshrrev_b32 v3, 4, v0
    v_cvt_f32_u32 v8, v2
    v_cvt_f32_u32 v9, v3
    v_lshrrev_b32 v12, 1, v0
    v_lshrrev_b32 v13, 2, v0
    v_and_b32 v13, 4, v13
    v_xor_b32 v12, v12, v13
    v_and_b32 v15, 7, v12
    s_and_b32 s57, s49, 3
    s_lshl2_add_u32 s54, s48, s57
    s_lshr_b32 s55, s49, 2
    s_lshl1_add_u32 s57, s57, s55
    s_and_b32 s19, s2, 15
    s_lshl_b32 s19, s19, 7
    s_add_u32 s19, s19, 7667712
    s_and_b32 s53, s2, 15
    s_lshl_b32 s53, s53, 4
    s_bfe_u32 s22, s2, 0x20004
    s_lshl2_add_u32 s53, s22, s53
    s_lshr_b32 s22, s2, 6
    s_add_u32 s53, s53, s22
    s_lshl_b32 s53, s53, 6
    v_lshlrev_b32 v12, 7, v0
    v_add_u32 v250, 7667712, v12
    v_mov_b32 v207, 4
    s_getreg_b32 s23, hwreg(HW_REG_XCC_ID)
    s_and_b32 s23, s23, 15
    s_cmp_eq_u32 s23, s48
    s_cselect_b32 s23, 1, 0x10001
    v_mov_b32 v108, s23
    v_and_b32 v199, 3, v2
    v_lshlrev_b32 v199, 8, v199
    v_and_b32 v198, 12, v2
    v_add_u32 v198, v198, v3
    v_lshl_add_u32 v199, v198, 4, v199
    v_lshlrev_b32 v248, 2, v0
    v_mov_b32 v206, 0
    s_lshl_b32 s22, s51, 11
    s_add_u32 s22, s22, s60
    s_add_u32 s22, s22, 8388608
    v_add_u32 v202, s22, v12
    s_lshl_b32 s22, s50, 7
    s_add_u32 s22, s22, 7671808
    v_writelane_b32 v202, s22, 16
    v_mov_b32 v249, v12
    s_lshl_b32 s21, s58, 14
    s_lshl_b32 s22, s55, 7
    s_add_u32 s21, s21, s22
    s_cmp_eq_u32 s58, 0
    s_cselect_b32 s17, 0, 0x40000000
    v_lshlrev_b32 v101, 2, v2
    v_lshl_add_u32 v101, v3, 10, v101
    s_mul_i32 s66, s52, 196608
    s_add_u32 m0, s64, 32768
    s_add_u32 s66, s66, s61
    buffer_load_dwordx4 v6, s[32:35], s66 offen  lds
    buffer_load_dwordx4 v6, s[32:35], s66 offen offset:1024  lds
    s_add_u32 s66, s66, 10240
    buffer_load_dwordx4 v6, s[32:35], s66 offen offset:2048  lds
    buffer_load_dwordx4 v6, s[32:35], s66 offen offset:3072  lds
    s_lshl_b32 s65, s52, 7
    s_add_u32 m0, s62, 81920
    s_add_u32 s65, s65, s60
    buffer_load_dwordx4 v5, s[28:31], s65 offen  lds
    s_add_u32 s65, s65, 7168
    buffer_load_dwordx4 v5, s[28:31], s65 offen offset:1024  lds
    s_add_u32 s52, s52, 1
    s_and_b32 s52, s52, 7
    s_waitcnt vmcnt(12)
    s_barrier
    s_mul_i32 s66, s52, 196608
    s_add_u32 m0, s64, 49152
    s_add_u32 s66, s66, s61
    buffer_load_dwordx4 v6, s[32:35], s66 offen  lds
    buffer_load_dwordx4 v6, s[32:35], s66 offen offset:1024  lds
    s_add_u32 s66, s66, 10240
    buffer_load_dwordx4 v6, s[32:35], s66 offen offset:2048  lds
    buffer_load_dwordx4 v6, s[32:35], s66 offen offset:3072  lds
    s_lshl_b32 s65, s52, 7
    s_add_u32 m0, s62, 90112
    s_add_u32 s65, s65, s60
    buffer_load_dwordx4 v5, s[28:31], s65 offen  lds
    s_add_u32 s65, s65, 7168
    buffer_load_dwordx4 v5, s[28:31], s65 offen offset:1024  lds
    s_add_u32 s52, s52, 1
    s_and_b32 s52, s52, 7
    s_waitcnt vmcnt(12)
    s_barrier
    s_cmp_eq_u32 s58, 0
    s_cbranch_scc0 L_NOSP2
    s_waitcnt vmcnt(63)
    s_lshl_b32 s14, s56, 11
    s_lshl_b32 s22, s69, 8
    s_add_u32 s14, s14, s22
    s_add_u32 s14, s14, 4718592
    s_lshl_b32 s15, s75, 19
    s_lshr_b32 s22, s59, 14
    s_add_u32 s15, s15, s22
    s_add_u32 s15, s15, s14
    s_lshr_b32 s22, s59, 24
    s_sub_u32 s14, s14, s22
    s_add_u32 s14, s14, 2097280
    s_cmp_eq_u32 s75, 0
    s_cselect_b32 s22, 0, 1.0
    v_lshl_or_b32 v196, v107, 16, v106
    v_lshlrev_b32 v192, 16, v192
    v_lshlrev_b32 v193, 16, v193
    v_lshlrev_b32 v106, 16, v106
    v_lshlrev_b32 v107, 16, v107
    v_fma_f32 v192, v106, s22, v192
    v_fma_f32 v193, -v107, s22, v193
    v_mul_f32 v192, 0.5, v192
    v_mul_f32 v193, 0.5, v193
    v_cvt_pk_bf16_f32 v192, v192, v193
    v_xor_b32 v196, s59, v196
    v_xor_b32 v192, s59, v192
    s_mov_b32 exec_hi, 0
    buffer_store_dword v192, v101, s[24:27], s15 offen sc1
    s_cbranch_scc0 L_NOSP3
    buffer_store_dword v196, v101, s[24:27], s14 offen sc1
L_NOSP3:
    s_mov_b32 exec_hi, -1
L_NOSP2:
    s_mov_b64 exec, 3
    buffer_load_dword v204, v249, s[44:47], s17 offen sc1
    s_mov_b64 exec, -1
    s_mul_i32 s66, s52, 196608
    s_add_u32 m0, s64, 0
    s_add_u32 s66, s66, s61
    buffer_load_dwordx4 v6, s[32:35], s66 offen  lds
    buffer_load_dwordx4 v6, s[32:35], s66 offen offset:1024  lds
    s_add_u32 s66, s66, 10240
    buffer_load_dwordx4 v6, s[32:35], s66 offen offset:2048  lds
    buffer_load_dwordx4 v6, s[32:35], s66 offen offset:3072  lds
    s_lshl_b32 s65, s52, 7
    s_add_u32 m0, s62, 98304
    s_add_u32 s65, s65, s60
    buffer_load_dwordx4 v5, s[28:31], s65 offen  lds
    s_add_u32 s65, s65, 7168
    buffer_load_dwordx4 v5, s[28:31], s65 offen offset:1024  lds
    s_add_u32 s52, s52, 1
    s_and_b32 s52, s52, 7
    s_waitcnt vmcnt(13)
    s_barrier
    s_mul_i32 s66, s52, 196608
    s_add_u32 m0, s64, 16384
    s_add_u32 s66, s66, s61
    buffer_load_dwordx4 v6, s[32:35], s66 offen  lds
    buffer_load_dwordx4 v6, s[32:35], s66 offen offset:1024  lds
    s_add_u32 s66, s66, 10240
    buffer_load_dwordx4 v6, s[32:35], s66 offen offset:2048  lds
    buffer_load_dwordx4 v6, s[32:35], s66 offen offset:3072  lds
    s_lshl_b32 s65, s52, 7
    s_add_u32 m0, s62, 106496
    s_add_u32 s65, s65, s60
    buffer_load_dwordx4 v5, s[28:31], s65 offen  lds
    s_add_u32 s65, s65, 7168
    buffer_load_dwordx4 v5, s[28:31], s65 offen offset:1024  lds
    s_add_u32 s52, s52, 1
    s_and_b32 s52, s52, 7
    s_waitcnt vmcnt(13)
    s_barrier
    s_mul_i32 s66, s52, 196608
    s_add_u32 m0, s64, 32768
    s_add_u32 s66, s66, s61
    buffer_load_dwordx4 v6, s[32:35], s66 offen  lds
    buffer_load_dwordx4 v6, s[32:35], s66 offen offset:1024  lds
    s_add_u32 s66, s66, 10240
    buffer_load_dwordx4 v6, s[32:35], s66 offen offset:2048  lds
    buffer_load_dwordx4 v6, s[32:35], s66 offen offset:3072  lds
    s_lshl_b32 s65, s52, 7
    s_add_u32 m0, s62, 114688
    s_add_u32 s65, s65, s60
    buffer_load_dwordx4 v5, s[28:31], s65 offen  lds
    s_add_u32 s65, s65, 7168
    buffer_load_dwordx4 v5, s[28:31], s65 offen offset:1024  lds
    s_add_u32 s52, s52, 1
    s_and_b32 s52, s52, 7
    s_waitcnt vmcnt(12)
    s_cmp_eq_u32 s58, 0
    s_cbranch_scc0 L_GOD
    s_mov_b64 exec, 3
L_GO:
    v_cmp_gt_u32 vcc, 41, v204
    s_cbranch_vccnz L_GORE
    s_mov_b64 exec, -1
L_GOD:
    s_barrier
    s_cmp_eq_u32 s58, 1
    s_cbranch_scc0 L_NOSG
    s_mov_b64 exec, 1
    buffer_atomic_add v108, v206, s[24:27], s19 offen sc0 sc1
    s_mov_b64 exec, -1
L_NOSG:
    s_mul_i32 s66, s52, 196608
    s_add_u32 m0, s64, 49152
    s_add_u32 s66, s66, s61
    buffer_load_dwordx4 v6, s[32:35], s66 offen  lds
    buffer_load_dwordx4 v6, s[32:35], s66 offen offset:1024  lds
    s_add_u32 s66, s66, 10240
    buffer_load_dwordx4 v6, s[32:35], s66 offen offset:2048  lds
    buffer_load_dwordx4 v6, s[32:35], s66 offen offset:3072  lds
    s_lshl_b32 s65, s52, 7
    s_add_u32 m0, s62, 122880
    s_add_u32 s65, s65, s60
    buffer_load_dwordx4 v5, s[28:31], s65 offen  lds
    s_add_u32 s65, s65, 7168
    buffer_load_dwordx4 v5, s[28:31], s65 offen offset:1024  lds
    s_add_u32 s52, s52, 1
    s_and_b32 s52, s52, 7
    s_waitcnt vmcnt(12)
    s_barrier
    s_sub_u32 s61, s61, 1024
    s_mul_i32 s66, s52, 196608
    s_add_u32 m0, s62, 0
    s_add_u32 s66, s66, s61
    s_add_u32 s52, s52, 1
    buffer_load_dwordx4 v6, s[32:35], s66 offen  lds
    s_add_u32 s66, s66, 11264
    s_and_b32 s52, s52, 7
    buffer_load_dwordx4 v6, s[32:35], s66 offen offset:1024  lds
    s_mul_i32 s66, s52, 196608
    s_add_u32 m0, s62, 8192
    s_add_u32 s66, s66, s61
    s_add_u32 s52, s52, 1
    buffer_load_dwordx4 v6, s[32:35], s66 offen  lds
    s_add_u32 s66, s66, 11264
    s_and_b32 s52, s52, 7
    buffer_load_dwordx4 v6, s[32:35], s66 offen offset:1024  lds
    s_waitcnt vmcnt(10)
    s_barrier
    s_mul_i32 s66, s52, 196608
    s_add_u32 m0, s62, 16384
    s_add_u32 s66, s66, s61
    s_add_u32 s52, s52, 1
    buffer_load_dwordx4 v6, s[32:35], s66 offen  lds
    s_add_u32 s66, s66, 11264
    s_and_b32 s52, s52, 7
    buffer_load_dwordx4 v6, s[32:35], s66 offen offset:1024  lds
    s_mul_i32 s66, s52, 196608
    s_add_u32 m0, s62, 24576
    s_add_u32 s66, s66, s61
    s_add_u32 s52, s52, 1
    buffer_load_dwordx4 v6, s[32:35], s66 offen  lds
    s_add_u32 s66, s66, 11264
    s_and_b32 s52, s52, 7
    buffer_load_dwordx4 v6, s[32:35], s66 offen offset:1024  lds
    s_waitcnt vmcnt(8)
    s_cmp_eq_u32 s58, 1
    s_cbranch_scc0 L_NOTK
    v_readfirstlane_b32 s22, v108
    s_nop 0
    s_and_b32 s22, s22, 0xffff
    s_and_b32 s23, s2, 15
    s_lshl4_add_u32 s22, s22, s23
    v_mov_b32 v108, s22
    s_barrier
    ds_write_b32 v254, v108 offset:60
    s_mov_b64 exec, 1
    ds_add_u32 v254, v207 offset:84
    s_mov_b64 exec, -1
    s_branch L_TKD
L_NOTK:
    s_barrier
L_TKD:
L_TKW:
    ds_read_b32 v253, v254 offset:84
    s_sub_u32 s74, s74, 1
    s_cbranch_scc1 L_END
    s_waitcnt lgkmcnt(0)
    v_cmp_ne_u32 vcc, 4, v253
    s_cbranch_vccnz L_TKW
    ds_read_b32 v1, v254 offset:60
    s_waitcnt lgkmcnt(0)
    v_readfirstlane_b32 s56, v1
    s_cmp_gt_u32 s56, 128
    s_cbranch_scc0 L_B2P
    s_mul_i32 s66, s52, 196608
    s_add_u32 m0, s62, 32768
    s_add_u32 s66, s66, s61
    s_add_u32 s52, s52, 1
    buffer_load_dwordx4 v6, s[32:35], s66 offen  lds
    s_add_u32 s66, s66, 11264
    s_and_b32 s52, s52, 7
    buffer_load_dwordx4 v6, s[32:35], s66 offen offset:1024  lds
    s_mul_i32 s66, s52, 196608
    s_add_u32 m0, s62, 40960
    s_add_u32 s66, s66, s61
    s_add_u32 s52, s52, 1
    buffer_load_dwordx4 v6, s[32:35], s66 offen  lds
    s_add_u32 s66, s66, 11264
    s_and_b32 s52, s52, 7
    buffer_load_dwordx4 v6, s[32:35], s66 offen offset:1024  lds
    s_mov_b64 exec, 0x1ffff
    buffer_load_dword v203, v202, s[24:27], 0 offen sc1
    s_mov_b64 exec, -1
    s_waitcnt vmcnt(9)
    s_mov_b64 exec, 1
    ds_add_u32 v254, v255 offset:32
    s_mov_b64 exec, -1
L_C7N:
    s_sleep 1
    ds_read_b32 v253, v254 offset:56
    s_sub_u32 s74, s74, 1
    s_cbranch_scc1 L_END
    s_waitcnt lgkmcnt(0)
    v_cmp_ne_u32 vcc, 4, v253
    s_cbranch_vccnz L_C7N
    s_mul_i32 s66, s52, 196608
    s_add_u32 m0, s62, 49152
    s_add_u32 s66, s66, s61
    s_add_u32 s52, s52, 1
    buffer_load_dwordx4 v6, s[32:35], s66 offen  lds
    s_add_u32 s66, s66, 11264
    s_and_b32 s52, s52, 7
    buffer_load_dwordx4 v6, s[32:35], s66 offen offset:1024  lds
    s_mul_i32 s66, s52, 196608
    s_add_u32 m0, s62, 57344
    s_add_u32 s66, s66, s61
    s_add_u32 s52, s52, 1
    buffer_load_dwordx4 v6, s[32:35], s66 offen  lds
    s_add_u32 s66, s66, 11264
    s_and_b32 s52, s52, 7
    buffer_load_dwordx4 v6, s[32:35], s66 offen offset:1024  lds
    s_add_u32 s5, s57, 0
    s_and_b32 s5, s5, 7
    s_lshl_b32 s5, s5, 16
    s_add_u32 m0, s62, 131072
    s_add_u32 s5, s5, s21
    buffer_load_dwordx4 v4, s[36:39], s5 offen lds
    s_add_u32 s5, s5, 3072
    buffer_load_dwordx4 v4, s[36:39], s5 offen offset:1024 lds
    s_add_u32 s5, s57, 1
    s_and_b32 s5, s5, 7
    s_lshl_b32 s5, s5, 16
    s_add_u32 m0, s62, 139264
    s_add_u32 s5, s5, s21
    buffer_load_dwordx4 v4, s[36:39], s5 offen lds
    s_add_u32 s5, s5, 3072
    buffer_load_dwordx4 v4, s[36:39], s5 offen offset:1024 lds
    s_sub_u32 s13, s56, 129
    s_lshl2_add_u32 s13, s13, s58
    s_mul_i32 s22, s13, 7282
    s_lshr_b32 s22, s22, 16
    s_mul_i32 s23, s22, 9
    s_sub_u32 s23, s13, s23
    s_lshl_b32 s8, s22, 14
    s_lshl_b32 s9, s23, 6
    s_add_u32 s8, s8, s9
    s_add_u32 s8, s8, 7077888
    s_lshl_b32 s9, s22, 11
    s_lshl_b32 s10, s23, 7
    s_add_u32 s10, s10, s9
    s_add_u32 s10, s10, 7012352
    s_add_u32 s9, s9, 7602176
    s_cmp_lt_u32 s23, 8
    s_cselect_b32 s8, s8, s9
    s_cselect_b32 s11, 0xffff0000, -1
    s_cselect_b32 s12, 9, 6
    s_cselect_b64 s[14:15], -1, 0
    s_lshl_b32 s9, 4, s12
    v_lshlrev_b32 v193, s12, v3
    v_lshl_add_u32 v193, v2, 2, v193
    s_waitcnt vmcnt(13)
    s_mov_b64 exec, 1
    ds_add_u32 v254, v255 offset:36
    s_mov_b64 exec, -1
    s_mov_b64 exec, 0xffff
    buffer_load_dword v205, v250, s[24:27], s17 offen sc1
    s_mov_b64 exec, -1
    s_waitcnt vmcnt(10)
    s_mov_b64 exec, 1
    ds_add_u32 v254, v255 offset:40
    s_mov_b64 exec, -1
    s_waitcnt vmcnt(5)
    s_mov_b64 exec, 1
    ds_add_u32 v254, v255 offset:44
    s_mov_b64 exec, -1
    s_cmp_eq_u32 s58, 0
    s_cbranch_scc0 L_H1OKN
    s_waitcnt vmcnt(0)
    s_mov_b64 exec, 0xffff
L_H1N:
    v_and_b32 v1, 0xffff, v205
    v_cmp_ne_u32 vcc, 16, v1
    s_cbranch_vccnz L_H1REN
    v_cmp_ne_u32 vcc, 16, v205
    s_nop 1
    v_mov_b32 v1, vcc_lo
    s_mov_b64 exec, 1
    ds_write_b32 v254, v1 offset:24
    ds_add_u32 v254, v207 offset:28
    s_mov_b64 exec, -1
L_H1OKN:
    s_setprio 3
    s_cmp_lt_u32 s13, 288
    s_cbranch_scc0 L_NORED
    s_mov_b32 s12, 1
L_RED:
    s_mov_b32 s22, s8
    buffer_load_dword v160, v193, s[24:27], s22 offen sc1
    s_add_u32 s22, s22, s9
    buffer_load_dword v161, v193, s[24:27], s22 offen sc1
    s_add_u32 s22, s22, s9
    buffer_load_dword v162, v193, s[24:27], s22 offen sc1
    s_add_u32 s22, s22, s9
    buffer_load_dword v163, v193, s[24:27], s22 offen sc1
    s_add_u32 s22, s22, s9
    buffer_load_dword v164, v193, s[24:27], s22 offen sc1
    s_add_u32 s22, s22, s9
    buffer_load_dword v165, v193, s[24:27], s22 offen sc1
    s_add_u32 s22, s22, s9
    buffer_load_dword v166, v193, s[24:27], s22 offen sc1
    s_add_u32 s22, s22, s9
    buffer_load_dword v167, v193, s[24:27], s22 offen sc1
    s_waitcnt vmcnt(0)
    s_sub_u32 s12, s12, 1
    s_cmp_eq_u32 s12, 0
    s_cbranch_scc0 L_RDS
    s_mov_b64 exec, 1
    ds_add_u32 v254, v255 offset:48
    s_mov_b64 exec, -1
L_RDS:
    v_max3_u32 v1, v160, v161, v162
    v_max3_u32 v168, v163, v164, v165
    v_max3_u32 v1, v1, v166, v167
    v_max_u32 v1, v1, v168
    v_cmp_eq_u32 vcc, -1, v1
    s_cbranch_vccnz L_REDRE
    v_lshlrev_b32 v168, 16, v160
    v_and_b32 v169, s11, v160
    v_lshlrev_b32 v170, 16, v161
    v_and_b32 v171, s11, v161
    v_lshlrev_b32 v172, 16, v162
    v_and_b32 v173, s11, v162
    v_lshlrev_b32 v174, 16, v163
    v_and_b32 v175, s11, v163
    v_lshlrev_b32 v176, 16, v164
    v_and_b32 v177, s11, v164
    v_lshlrev_b32 v178, 16, v165
    v_and_b32 v179, s11, v165
    v_lshlrev_b32 v180, 16, v166
    v_and_b32 v181, s11, v166
    v_lshlrev_b32 v182, 16, v167
    v_and_b32 v183, s11, v167
    v_pk_add_f32 v[168:169], v[168:169], v[176:177]
    v_pk_add_f32 v[170:171], v[170:171], v[178:179]
    v_pk_add_f32 v[172:173], v[172:173], v[180:181]
    v_pk_add_f32 v[174:175], v[174:175], v[182:183]
    v_pk_add_f32 v[168:169], v[168:169], v[172:173]
    v_pk_add_f32 v[170:171], v[170:171], v[174:175]
    v_pk_add_f32 v[168:169], v[168:169], v[170:171]
    v_mov_b32 v170, v168
    v_mov_b32 v171, v169
    s_nop 0
    v_permlane32_swap_b32 v168, v170
    v_permlane32_swap_b32 v169, v171
    v_pk_add_f32 v[168:169], v[168:169], v[170:171]
    v_mov_b32 v170, v168
    v_mov_b32 v171, v169
    s_nop 0
    v_permlane16_swap_b32 v168, v170
    v_permlane16_swap_b32 v169, v171
    v_pk_add_f32 v[168:169], v[168:169], v[170:171]
    v_cvt_pk_bf16_f32 v168, v168, v169
    v_cndmask_b32 v168, v169, v168, s[14:15]
    v_min_u32 v168, -2, v168
    s_mov_b64 exec, 0xffff
    buffer_store_dword v168, v193, s[24:27], s10 offen sc1
    s_mov_b64 exec, 1
    s_cmp_gt_i32 s12, 0
    s_cbranch_scc0 L_RDT
    ds_add_u32 v254, v255 offset:48
L_RDT:
    s_mov_b64 exec, -1
L_NORED:
    s_waitcnt vmcnt(1)
    s_mov_b64 exec, 1
    ds_add_u32 v254, v255 offset:76
    s_mov_b64 exec, -1
    s_branch L_NOB2
L_B2P:
    s_mul_i32 s66, s52, 196608
    s_add_u32 m0, s62, 32768
    s_add_u32 s66, s66, s61
    s_add_u32 s52, s52, 1
    buffer_load_dwordx4 v6, s[32:35], s66 offen  lds
    s_add_u32 s66, s66, 11264
    s_and_b32 s52, s52, 7
    buffer_load_dwordx4 v6, s[32:35], s66 offen offset:1024  lds
    s_mul_i32 s66, s52, 196608
    s_add_u32 m0, s62, 40960
    s_add_u32 s66, s66, s61
    s_add_u32 s52, s52, 1
    buffer_load_dwordx4 v6, s[32:35], s66 offen  lds
    s_add_u32 s66, s66, 11264
    s_and_b32 s52, s52, 7
    buffer_load_dwordx4 v6, s[32:35], s66 offen offset:1024  lds
    s_mov_b64 exec, 0x1ffff
    buffer_load_dword v203, v202, s[24:27], 0 offen sc1
    s_mov_b64 exec, -1
    s_waitcnt vmcnt(9)
    s_mov_b64 exec, 1
    ds_add_u32 v254, v255 offset:32
    s_mov_b64 exec, -1
L_C7B:
    s_sleep 1
    ds_read_b32 v253, v254 offset:56
    s_sub_u32 s74, s74, 1
    s_cbranch_scc1 L_END
    s_waitcnt lgkmcnt(0)
    v_cmp_ne_u32 vcc, 4, v253
    s_cbranch_vccnz L_C7B
    s_mul_i32 s66, s52, 196608
    s_add_u32 m0, s62, 49152
    s_add_u32 s66, s66, s61
    s_add_u32 s52, s52, 1
    buffer_load_dwordx4 v6, s[32:35], s66 offen  lds
    s_add_u32 s66, s66, 11264
    s_and_b32 s52, s52, 7
    buffer_load_dwordx4 v6, s[32:35], s66 offen offset:1024  lds
    s_mul_i32 s66, s52, 196608
    s_add_u32 m0, s62, 57344
    s_add_u32 s66, s66, s61
    s_add_u32 s52, s52, 1
    buffer_load_dwordx4 v6, s[32:35], s66 offen  lds
    s_add_u32 s66, s66, 11264
    s_and_b32 s52, s52, 7
    buffer_load_dwordx4 v6, s[32:35], s66 offen offset:1024  lds
    s_add_u32 s5, s57, 0
    s_and_b32 s5, s5, 7
    s_lshl_b32 s5, s5, 16
    s_add_u32 m0, s62, 131072
    s_add_u32 s5, s5, s21
    buffer_load_dwordx4 v4, s[36:39], s5 offen lds
    s_add_u32 s5, s5, 3072
    buffer_load_dwordx4 v4, s[36:39], s5 offen offset:1024 lds
    s_add_u32 s5, s57, 1
    s_and_b32 s5, s5, 7
    s_lshl_b32 s5, s5, 16
    s_add_u32 m0, s62, 139264
    s_add_u32 s5, s5, s21
    buffer_load_dwordx4 v4, s[36:39], s5 offen lds
    s_add_u32 s5, s5, 3072
    buffer_load_dwordx4 v4, s[36:39], s5 offen offset:1024 lds
    v_pk_mul_f32 v[16:17], v[254:255], 0
    v_pk_mul_f32 v[18:19], v[254:255], 0
    v_pk_mul_f32 v[20:21], v[254:255], 0
    v_pk_mul_f32 v[22:23], v[254:255], 0
    v_pk_mul_f32 v[24:25], v[254:255], 0
    v_pk_mul_f32 v[26:27], v[254:255], 0
    v_pk_mul_f32 v[28:29], v[254:255], 0
    v_pk_mul_f32 v[30:31], v[254:255], 0
    v_pk_mul_f32 v[32:33], v[254:255], 0
    v_pk_mul_f32 v[34:35], v[254:255], 0
    v_pk_mul_f32 v[36:37], v[254:255], 0
    v_pk_mul_f32 v[38:39], v[254:255], 0
    v_pk_mul_f32 v[40:41], v[254:255], 0
    v_pk_mul_f32 v[42:43], v[254:255], 0
    v_pk_mul_f32 v[44:45], v[254:255], 0
    v_pk_mul_f32 v[46:47], v[254:255], 0
    s_mov_b64 s[28:29], s[0:1]
    s_mov_b64 s[44:45], s[70:71]
    s_mov_b32 s30, 1052672
    s_mov_b32 s46, 1052672
    s_bfe_u32 s22, s56, 0x40003
    s_and_b32 s23, s56, 4
    s_lshl2_add_u32 s22, s23, s22
    s_lshr_b32 s4, s22, 1
    s_and_b32 s23, s56, 8
    s_lshl1_add_u32 s4, s23, s4
    s_and_b32 s23, s56, 0x80
    s_add_u32 s4, s4, s23
    s_lshl_b32 s22, s22, 4
    s_and_b32 s23, s56, 3
    s_lshl_b32 s69, s23, 5
    s_add_u32 s4, s4, s69
    s_cmp_ge_u32 s22, 256
    s_cselect_b32 s69, 4, 0
    s_cselect_b32 s59, 0x80000000, 0
    s_cselect_b64 vcc, -1, 0
    s_cselect_b32 s68, 209712, 0
    s_movk_i32 s67, 4112
    s_cmovk_i32 s67, -4112
    s_cmp_eq_u32 s23, 0
    s_cselect_b32 s23, s69, s23
    s_lshl_b32 s69, s58, 5
    s_add_u32 s69, s69, s23
    v_lshlrev_b32 v100, 9, v3
    v_add_u32 v100, s69, v100
    v_add_u32 v101, s22, v2
    v_sub_u32 v102, 1640, v100
    v_sub_u32 v103, 0x200, v101
    v_cndmask_b32 v100, v100, v102, vcc
    v_cndmask_b32 v101, v101, v103, vcc
    v_mul_u32_u24 v100, 514, v100
    v_lshl_add_u32 v197, v101, 1, v100
    s_and_b32 s22, s22, 0xff
    s_cmp_eq_u32 s22, 0
    s_cselect_b32 s75, 4718592, 2.0
    s_cselect_b32 s6, 0x10001, 0
    s_cmp_eq_u32 s56, 128
    s_cselect_b32 s6, -1, s6
    s_cselect_b32 s68, 2.0, s68
    s_mul_i32 s69, s67, 13
    s_lshl_b32 s20, s4, 14
    s_add_u32 s20, s20, s64
    s_waitcnt vmcnt(13)
    s_mov_b64 exec, 1
    ds_add_u32 v254, v255 offset:36
    s_mov_b64 exec, -1
    s_lshl_b32 s22, s58, 2
    v_cvt_f32_u32 v146, s22
    v_mul_f32 v144, 0x3d800000, v8
    v_mul_f32 v145, 4.0, v9
    v_mul_f32 v145, v145, v144
    v_mul_f32 v147, 0x3d800000, v144
    v_mul_f32 v146, v146, v147
    v_cos_f32 v154, v145
    v_sin_f32 v155, v145
    v_add_f32 v148, v145, v146
    v_cvt_pk_bf16_f32 v240, v154, v155
    v_cvt_pk_bf16_f32 v244, -v155, v154
    v_cos_f32 v150, v148
    v_sin_f32 v151, v148
    v_add_f32 v148, v148, v147
    v_cvt_pk_bf16_f32 v208, v150, v151
    v_cvt_pk_bf16_f32 v212, -v151, v150
    v_cos_f32 v152, v148
    v_sin_f32 v153, v148
    v_add_f32 v148, v148, v147
    v_cvt_pk_bf16_f32 v216, v152, v153
    v_cvt_pk_bf16_f32 v220, -v153, v152
    v_cos_f32 v150, v148
    v_sin_f32 v151, v148
    v_add_f32 v148, v148, v147
    v_cvt_pk_bf16_f32 v224, v150, v151
    v_cvt_pk_bf16_f32 v228, -v151, v150
    v_cos_f32 v152, v148
    v_sin_f32 v153, v148
    v_add_f32 v145, v145, v144
    v_cvt_pk_bf16_f32 v232, v152, v153
    v_cvt_pk_bf16_f32 v236, -v153, v152
    v_cos_f32 v154, v145
    v_sin_f32 v155, v145
    v_add_f32 v148, v145, v146
    v_cvt_pk_bf16_f32 v241, v154, v155
    v_cvt_pk_bf16_f32 v245, -v155, v154
    v_cos_f32 v150, v148
    v_sin_f32 v151, v148
    v_add_f32 v148, v148, v147
    v_cvt_pk_bf16_f32 v209, v150, v151
    v_cvt_pk_bf16_f32 v213, -v151, v150
    v_cos_f32 v152, v148
    v_sin_f32 v153, v148
    v_add_f32 v148, v148, v147
    v_cvt_pk_bf16_f32 v217, v152, v153
    v_cvt_pk_bf16_f32 v221, -v153, v152
    v_cos_f32 v150, v148
    v_sin_f32 v151, v148
    v_add_f32 v148, v148, v147
    v_cvt_pk_bf16_f32 v225, v150, v151
    v_cvt_pk_bf16_f32 v229, -v151, v150
    v_cos_f32 v152, v148
    v_sin_f32 v153, v148
    v_add_f32 v145, v145, v144
    v_cvt_pk_bf16_f32 v233, v152, v153
    v_cvt_pk_bf16_f32 v237, -v153, v152
    v_cos_f32 v154, v145
    v_sin_f32 v155, v145
    v_add_f32 v148, v145, v146
    s_waitcnt vmcnt(9)
    s_mov_b64 exec, 1
    ds_add_u32 v254, v255 offset:40
    s_mov_b64 exec, -1
    s_mov_b64 exec, 0xffff
    buffer_load_dword v205, v250, s[24:27], s17 offen sc1
    s_mov_b64 exec, -1
    s_setprio 3
    buffer_load_short_d16_hi v16, v197, s[28:31], s68 offen
    buffer_load_short_d16_hi v20, v197, s[44:47], s68 offen
    s_add_u32 s68, s68, s67
    buffer_load_short_d16_hi v24, v197, s[28:31], s68 offen
    buffer_load_short_d16_hi v28, v197, s[44:47], s68 offen
    s_add_u32 s68, s68, s67
    buffer_load_short_d16_hi v32, v197, s[28:31], s68 offen
    buffer_load_short_d16_hi v36, v197, s[44:47], s68 offen
    s_add_u32 s68, s68, s67
    buffer_load_short_d16_hi v40, v197, s[28:31], s68 offen
    buffer_load_short_d16_hi v44, v197, s[44:47], s68 offen
    s_add_u32 s68, s68, s69
    s_waitcnt vmcnt(13)
    s_mov_b64 exec, 1
    ds_add_u32 v254, v255 offset:44
    s_mov_b64 exec, -1
    buffer_load_short_d16_hi v17, v197, s[28:31], s68 offen
    buffer_load_short_d16_hi v21, v197, s[44:47], s68 offen
    s_add_u32 s68, s68, s67
    buffer_load_short_d16_hi v25, v197, s[28:31], s68 offen
    buffer_load_short_d16_hi v29, v197, s[44:47], s68 offen
    s_add_u32 s68, s68, s67
    buffer_load_short_d16_hi v33, v197, s[28:31], s68 offen
    buffer_load_short_d16_hi v37, v197, s[44:47], s68 offen
    s_add_u32 s68, s68, s67
    buffer_load_short_d16_hi v41, v197, s[28:31], s68 offen
    buffer_load_short_d16_hi v45, v197, s[44:47], s68 offen
    s_add_u32 s68, s68, s69
    v_cvt_pk_bf16_f32 v242, v154, v155
    v_cvt_pk_bf16_f32 v246, -v155, v154
    v_cos_f32 v150, v148
    v_sin_f32 v151, v148
    v_add_f32 v148, v148, v147
    v_cvt_pk_bf16_f32 v210, v150, v151
    v_cvt_pk_bf16_f32 v214, -v151, v150
    v_cos_f32 v152, v148
    v_sin_f32 v153, v148
    v_add_f32 v148, v148, v147
    v_cvt_pk_bf16_f32 v218, v152, v153
    v_cvt_pk_bf16_f32 v222, -v153, v152
    v_cos_f32 v150, v148
    v_sin_f32 v151, v148
    v_add_f32 v148, v148, v147
    v_cvt_pk_bf16_f32 v226, v150, v151
    v_cvt_pk_bf16_f32 v230, -v151, v150
    v_cos_f32 v152, v148
    v_sin_f32 v153, v148
    v_add_f32 v145, v145, v144
    v_cvt_pk_bf16_f32 v234, v152, v153
    v_cvt_pk_bf16_f32 v238, -v153, v152
    v_cos_f32 v154, v145
    v_sin_f32 v155, v145
    v_add_f32 v148, v145, v146
    v_cvt_pk_bf16_f32 v243, v154, v155
    v_cvt_pk_bf16_f32 v247, -v155, v154
    v_cos_f32 v150, v148
    v_sin_f32 v151, v148
    v_add_f32 v148, v148, v147
    v_cvt_pk_bf16_f32 v211, v150, v151
    v_cvt_pk_bf16_f32 v215, -v151, v150
    v_cos_f32 v152, v148
    v_sin_f32 v153, v148
    v_add_f32 v148, v148, v147
    v_cvt_pk_bf16_f32 v219, v152, v153
    v_cvt_pk_bf16_f32 v223, -v153, v152
    v_cos_f32 v150, v148
    v_sin_f32 v151, v148
    v_add_f32 v148, v148, v147
    v_cvt_pk_bf16_f32 v227, v150, v151
    v_cvt_pk_bf16_f32 v231, -v151, v150
    v_cos_f32 v152, v148
    v_sin_f32 v153, v148
    s_nop 0
    v_cvt_pk_bf16_f32 v235, v152, v153
    v_cvt_pk_bf16_f32 v239, -v153, v152
    s_lshl_b32 s23, s58, 8
    v_lshlrev_b32 v200, 12, v3
    v_lshl_add_u32 v200, v2, 4, v200
    v_add_u32 v200, s23, v200
    v_add_u32 v201, s64, v7
    v_add_u32 v251, 147456, v200
    v_add_u32 v252, 147456, v201
    s_cmp_eq_u32 s58, 3
    s_cselect_b32 s16, 0xffff, -1
    s_mov_b32 s7, 0xffff0000
    s_cmp_eq_u32 s58, 0
    s_cbranch_scc0 L_H1OKB
    s_waitcnt vmcnt(16)
    s_mov_b64 exec, 0xffff
L_H1B:
    v_and_b32 v1, 0xffff, v205
    v_cmp_ne_u32 vcc, 16, v1
    s_cbranch_vccnz L_H1REB
    v_cmp_ne_u32 vcc, 16, v205
    s_nop 1
    v_mov_b32 v1, vcc_lo
    s_mov_b64 exec, 1
    ds_write_b32 v254, v1 offset:24
    ds_add_u32 v254, v207 offset:28
    s_mov_b64 exec, -1
L_H1OKB:
L_G0W:
    s_sleep 1
    ds_read_b32 v253, v254 offset:64
    s_sub_u32 s74, s74, 1
    s_cbranch_scc1 L_END
    s_waitcnt lgkmcnt(0)
    v_cmp_ne_u32 vcc, 4, v253
    s_cbranch_vccnz L_G0W
L_H1W:
    ds_read_b32 v253, v254 offset:28
    s_sub_u32 s74, s74, 1
    s_cbranch_scc1 L_END
    s_waitcnt lgkmcnt(0)
    v_cmp_ne_u32 vcc, 4, v253
    s_cbranch_vccnz L_H1W
    s_mov_b32 m0, s64
    s_nop 0
    buffer_load_dwordx4 v7, s[24:27], s20 offen offset:0 sc1 lds
    buffer_load_dwordx4 v7, s[24:27], s20 offen offset:1024 sc1 lds
    buffer_load_dwordx4 v7, s[24:27], s20 offen offset:2048 sc1 lds
    buffer_load_dwordx4 v7, s[24:27], s20 offen offset:3072 sc1 lds
    s_add_u32 s23, s20, s75
    buffer_load_dwordx4 v[96:99], v7, s[24:27], s23 offen offset:0 sc1
    buffer_load_dwordx4 v[100:103], v7, s[24:27], s23 offen offset:1024 sc1
    buffer_load_dwordx4 v[104:107], v7, s[24:27], s23 offen offset:2048 sc1
    buffer_load_dwordx4 v[108:111], v7, s[24:27], s23 offen offset:3072 sc1
    buffer_load_short_d16_hi v18, v197, s[28:31], s68 offen
    buffer_load_short_d16_hi v22, v197, s[44:47], s68 offen
    s_add_u32 s68, s68, s67
    buffer_load_short_d16_hi v26, v197, s[28:31], s68 offen
    buffer_load_short_d16_hi v30, v197, s[44:47], s68 offen
    s_add_u32 s68, s68, s67
    buffer_load_short_d16_hi v34, v197, s[28:31], s68 offen
    buffer_load_short_d16_hi v38, v197, s[44:47], s68 offen
    s_add_u32 s68, s68, s67
    buffer_load_short_d16_hi v42, v197, s[28:31], s68 offen
    buffer_load_short_d16_hi v46, v197, s[44:47], s68 offen
    s_add_u32 s68, s68, s69
    buffer_load_short_d16_hi v19, v197, s[28:31], s68 offen
    buffer_load_short_d16_hi v23, v197, s[44:47], s68 offen
    s_add_u32 s68, s68, s67
    buffer_load_short_d16_hi v27, v197, s[28:31], s68 offen
    buffer_load_short_d16_hi v31, v197, s[44:47], s68 offen
    s_add_u32 s68, s68, s67
    buffer_load_short_d16_hi v35, v197, s[28:31], s68 offen
    buffer_load_short_d16_hi v39, v197, s[44:47], s68 offen
    s_add_u32 s68, s68, s67
    buffer_load_short_d16_hi v43, v197, s[28:31], s68 offen
    buffer_load_short_d16_hi v47, v197, s[44:47], s68 offen
    s_mov_b64 exec, 1
    ds_add_u32 v254, v255 offset:48
    s_mov_b64 exec, -1
    s_waitcnt vmcnt(41)
    s_mov_b64 exec, 1
    ds_add_u32 v254, v255 offset:76
    s_mov_b64 exec, -1
    v_add_u32 v198, s64, v248
    s_waitcnt vmcnt(23)
    ds_read_b32 v80, v198 offset:0
    ds_read_b32 v81, v198 offset:256
    ds_read_b32 v82, v198 offset:512
    ds_read_b32 v83, v198 offset:768
    s_waitcnt vmcnt(22)
    ds_read_b32 v84, v198 offset:1024
    ds_read_b32 v85, v198 offset:1280
    ds_read_b32 v86, v198 offset:1536
    ds_read_b32 v87, v198 offset:1792
    s_waitcnt vmcnt(21)
    ds_read_b32 v88, v198 offset:2048
    ds_read_b32 v89, v198 offset:2304
    ds_read_b32 v90, v198 offset:2560
    ds_read_b32 v91, v198 offset:2816
    s_waitcnt vmcnt(20)
    s_waitcnt lgkmcnt(8)
    ds_read_b32 v92, v198 offset:3072
    ds_read_b32 v93, v198 offset:3328
    ds_read_b32 v94, v198 offset:3584
    ds_read_b32 v95, v198 offset:3840
    s_waitcnt lgkmcnt(12)
    v_mfma_f32_16x16x32_bf16 v[112:115], v[208:211], v[80:83], 0
    v_mfma_f32_16x16x32_bf16 v[116:119], v[212:215], v[80:83], 0
    s_waitcnt lgkmcnt(8)
    v_mfma_f32_16x16x32_bf16 v[120:123], v[216:219], v[84:87], 0
    v_mfma_f32_16x16x32_bf16 v[124:127], v[220:223], v[84:87], 0
    s_waitcnt lgkmcnt(4)
    v_mfma_f32_16x16x32_bf16 v[128:131], v[224:227], v[88:91], 0
    v_mfma_f32_16x16x32_bf16 v[132:135], v[228:231], v[88:91], 0
    s_waitcnt lgkmcnt(0)
    v_mfma_f32_16x16x32_bf16 v[136:139], v[232:235], v[92:95], 0
    v_mfma_f32_16x16x32_bf16 v[140:143], v[236:239], v[92:95], 0
    v_cvt_pk_bf16_f32 v144, v112, v116
    v_cvt_pk_bf16_f32 v148, v113, v117
    v_cvt_pk_bf16_f32 v152, v114, v118
    v_cvt_pk_bf16_f32 v156, v115, v119
    v_cvt_pk_bf16_f32 v145, v120, v124
    v_cvt_pk_bf16_f32 v149, v121, v125
    v_cvt_pk_bf16_f32 v153, v122, v126
    v_cvt_pk_bf16_f32 v157, v123, v127
    v_cvt_pk_bf16_f32 v146, v128, v132
    v_cvt_pk_bf16_f32 v150, v129, v133
    v_cvt_pk_bf16_f32 v154, v130, v134
    v_cvt_pk_bf16_f32 v158, v131, v135
    v_cvt_pk_bf16_f32 v147, v136, v140
    v_cvt_pk_bf16_f32 v151, v137, v141
    v_cvt_pk_bf16_f32 v155, v138, v142
    v_cvt_pk_bf16_f32 v159, v139, v143
    ds_write_b128 v251, v[144:147] offset:0
    ds_write_b128 v251, v[148:151] offset:1024
    ds_write_b128 v251, v[152:155] offset:2048
    s_mov_b32 exec_hi, s16
    ds_write_b128 v251, v[156:159] offset:3072
    s_waitcnt lgkmcnt(0)
    s_mov_b64 exec, 1
    ds_add_u32 v254, v255 offset:12
    s_mov_b64 exec, -1
    v_mov_b32 v92, v156
    v_mov_b32 v93, v157
    v_mov_b32 v94, v158
    v_mov_b32 v95, v159
L_E1:
    ds_read_b32 v253, v254 offset:12
    s_sub_u32 s74, s74, 1
    s_cbranch_scc1 L_END
    s_waitcnt lgkmcnt(0)
    v_cmp_ne_u32 vcc, 4, v253
    s_cbranch_vccnz L_E1
    ds_read_b128 v[80:83], v252 offset:0
    ds_read_b128 v[84:87], v252 offset:1024
    ds_read_b128 v[88:91], v252 offset:2048
    s_mov_b32 exec_hi, s16
    ds_read_b128 v[92:95], v252 offset:3072
    s_mov_b32 exec_hi, -1
    s_waitcnt lgkmcnt(3)
    v_mfma_f32_16x16x32_bf16 v[112:115], v[240:243], v[80:83], 0
    v_mfma_f32_16x16x32_bf16 v[116:119], v[244:247], v[80:83], 0
    s_waitcnt lgkmcnt(2)
    v_mfma_f32_16x16x32_bf16 v[120:123], v[240:243], v[84:87], 0
    v_mfma_f32_16x16x32_bf16 v[124:127], v[244:247], v[84:87], 0
    s_waitcnt lgkmcnt(1)
    v_mfma_f32_16x16x32_bf16 v[128:131], v[240:243], v[88:91], 0
    v_mfma_f32_16x16x32_bf16 v[132:135], v[244:247], v[88:91], 0
    s_waitcnt lgkmcnt(0)
    v_mfma_f32_16x16x32_bf16 v[136:139], v[240:243], v[92:95], 0
    v_mfma_f32_16x16x32_bf16 v[140:143], v[244:247], v[92:95], 0
    s_waitcnt vmcnt(0)
    v_xor_b32 v20, s59, v20
    v_xor_b32 v21, s59, v21
    v_xor_b32 v22, s59, v22
    v_xor_b32 v23, s59, v23
    v_xor_b32 v28, s59, v28
    v_xor_b32 v29, s59, v29
    v_xor_b32 v30, s59, v30
    v_xor_b32 v31, s59, v31
    v_xor_b32 v36, s59, v36
    v_xor_b32 v37, s59, v37
    v_xor_b32 v38, s59, v38
    v_xor_b32 v39, s59, v39
    v_xor_b32 v44, s59, v44
    v_xor_b32 v45, s59, v45
    v_xor_b32 v46, s59, v46
    v_xor_b32 v47, s59, v47
    s_cmp_eq_u32 s6, 0
    s_cbranch_scc1 L_NOOV
    s_mov_b32 exec_lo, s6
    s_mov_b32 exec_hi, s6
    v_lshlrev_b32 v16, 16, v96
    v_and_b32 v20, s7, v96
    v_lshlrev_b32 v17, 16, v97
    v_and_b32 v21, s7, v97
    v_lshlrev_b32 v18, 16, v98
    v_and_b32 v22, s7, v98
    v_lshlrev_b32 v19, 16, v99
    v_and_b32 v23, s7, v99
    v_lshlrev_b32 v24, 16, v100
    v_and_b32 v28, s7, v100
    v_lshlrev_b32 v25, 16, v101
    v_and_b32 v29, s7, v101
    v_lshlrev_b32 v26, 16, v102
    v_and_b32 v30, s7, v102
    v_lshlrev_b32 v27, 16, v103
    v_and_b32 v31, s7, v103
    v_lshlrev_b32 v32, 16, v104
    v_and_b32 v36, s7, v104
    v_lshlrev_b32 v33, 16, v105
    v_and_b32 v37, s7, v105
    v_lshlrev_b32 v34, 16, v106
    v_and_b32 v38, s7, v106
    v_lshlrev_b32 v35, 16, v107
    v_and_b32 v39, s7, v107
    v_lshlrev_b32 v40, 16, v108
    v_and_b32 v44, s7, v108
    v_lshlrev_b32 v41, 16, v109
    v_and_b32 v45, s7, v109
    v_lshlrev_b32 v42, 16, v110
    v_and_b32 v46, s7, v110
    v_lshlrev_b32 v43, 16, v111
    v_and_b32 v47, s7, v111
    s_mov_b64 exec, -1
L_NOOV:
    v_pk_mul_f32 v[176:177], v[112:113], v[16:17]
    v_pk_mul_f32 v[180:181], v[116:117], v[16:17]
    v_pk_mul_f32 v[178:179], v[114:115], v[18:19]
    v_pk_mul_f32 v[182:183], v[118:119], v[18:19]
    v_pk_fma_f32 v[176:177], v[116:117], v[20:21], v[176:177] neg_lo:[1,0,0] neg_hi:[1,0,0]
    v_pk_fma_f32 v[180:181], v[112:113], v[20:21], v[180:181]
    v_pk_fma_f32 v[178:179], v[118:119], v[22:23], v[178:179] neg_lo:[1,0,0] neg_hi:[1,0,0]
    v_pk_fma_f32 v[182:183], v[114:115], v[22:23], v[182:183]
    v_cvt_pk_bf16_f32 v80, v176, -v180
    v_cvt_pk_bf16_f32 v81, v177, -v181
    v_cvt_pk_bf16_f32 v82, v178, -v182
    v_cvt_pk_bf16_f32 v83, v179, -v183
    v_pk_mul_f32 v[184:185], v[120:121], v[24:25]
    v_pk_mul_f32 v[188:189], v[124:125], v[24:25]
    v_pk_mul_f32 v[186:187], v[122:123], v[26:27]
    v_pk_mul_f32 v[190:191], v[126:127], v[26:27]
    v_pk_fma_f32 v[184:185], v[124:125], v[28:29], v[184:185] neg_lo:[1,0,0] neg_hi:[1,0,0]
    v_pk_fma_f32 v[188:189], v[120:121], v[28:29], v[188:189]
    v_pk_fma_f32 v[186:187], v[126:127], v[30:31], v[186:187] neg_lo:[1,0,0] neg_hi:[1,0,0]
    v_pk_fma_f32 v[190:191], v[122:123], v[30:31], v[190:191]
    v_cvt_pk_bf16_f32 v84, v184, -v188
    v_cvt_pk_bf16_f32 v85, v185, -v189
    v_cvt_pk_bf16_f32 v86, v186, -v190
    v_cvt_pk_bf16_f32 v87, v187, -v191
    v_mfma_f32_16x16x32_bf16 v[112:115], v[208:211], v[80:83], 0
    v_mfma_f32_16x16x32_bf16 v[116:119], v[212:215], v[80:83], 0
    v_pk_mul_f32 v[176:177], v[128:129], v[32:33]
    v_pk_mul_f32 v[180:181], v[132:133], v[32:33]
    v_pk_mul_f32 v[178:179], v[130:131], v[34:35]
    v_pk_mul_f32 v[182:183], v[134:135], v[34:35]
    v_pk_fma_f32 v[176:177], v[132:133], v[36:37], v[176:177] neg_lo:[1,0,0] neg_hi:[1,0,0]
    v_pk_fma_f32 v[180:181], v[128:129], v[36:37], v[180:181]
    v_pk_fma_f32 v[178:179], v[134:135], v[38:39], v[178:179] neg_lo:[1,0,0] neg_hi:[1,0,0]
    v_pk_fma_f32 v[182:183], v[130:131], v[38:39], v[182:183]
    v_cvt_pk_bf16_f32 v88, v176, -v180
    v_cvt_pk_bf16_f32 v89, v177, -v181
    v_cvt_pk_bf16_f32 v90, v178, -v182
    v_cvt_pk_bf16_f32 v91, v179, -v183
    v_mfma_f32_16x16x32_bf16 v[120:123], v[216:219], v[84:87], 0
    v_mfma_f32_16x16x32_bf16 v[124:127], v[220:223], v[84:87], 0
    v_pk_mul_f32 v[184:185], v[136:137], v[40:41]
    v_pk_mul_f32 v[188:189], v[140:141], v[40:41]
    v_pk_mul_f32 v[186:187], v[138:139], v[42:43]
    v_pk_mul_f32 v[190:191], v[142:143], v[42:43]
    v_pk_fma_f32 v[184:185], v[140:141], v[44:45], v[184:185] neg_lo:[1,0,0] neg_hi:[1,0,0]
    v_pk_fma_f32 v[188:189], v[136:137], v[44:45], v[188:189]
    v_pk_fma_f32 v[186:187], v[142:143], v[46:47], v[186:187] neg_lo:[1,0,0] neg_hi:[1,0,0]
    v_pk_fma_f32 v[190:191], v[138:139], v[46:47], v[190:191]
    v_cvt_pk_bf16_f32 v92, v184, -v188
    v_cvt_pk_bf16_f32 v93, v185, -v189
    v_cvt_pk_bf16_f32 v94, v186, -v190
    v_cvt_pk_bf16_f32 v95, v187, -v191
    v_mfma_f32_16x16x32_bf16 v[128:131], v[224:227], v[88:91], 0
    v_mfma_f32_16x16x32_bf16 v[132:135], v[228:231], v[88:91], 0
    v_mfma_f32_16x16x32_bf16 v[136:139], v[232:235], v[92:95], 0
    v_mfma_f32_16x16x32_bf16 v[140:143], v[236:239], v[92:95], 0
L_XW:
    ds_read_b32 v253, v254 offset:80
    s_sub_u32 s74, s74, 1
    s_cbranch_scc1 L_END
    s_waitcnt lgkmcnt(0)
    v_cmp_ne_u32 vcc, 4, v253
    s_cbranch_vccnz L_XW
    v_cvt_pk_bf16_f32 v144, v112, v116
    v_cvt_pk_bf16_f32 v148, v113, v117
    v_cvt_pk_bf16_f32 v152, v114, v118
    v_cvt_pk_bf16_f32 v156, v115, v119
    v_cvt_pk_bf16_f32 v145, v120, v124
    v_cvt_pk_bf16_f32 v149, v121, v125
    v_cvt_pk_bf16_f32 v153, v122, v126
    v_cvt_pk_bf16_f32 v157, v123, v127
    v_cvt_pk_bf16_f32 v146, v128, v132
    v_cvt_pk_bf16_f32 v150, v129, v133
    v_cvt_pk_bf16_f32 v154, v130, v134
    v_cvt_pk_bf16_f32 v158, v131, v135
    v_cvt_pk_bf16_f32 v147, v136, v140
    v_cvt_pk_bf16_f32 v151, v137, v141
    v_cvt_pk_bf16_f32 v155, v138, v142
    v_cvt_pk_bf16_f32 v159, v139, v143
    ds_write_b128 v200, v[144:147] offset:16384
    ds_write_b128 v200, v[148:151] offset:17408
    ds_write_b128 v200, v[152:155] offset:18432
    ds_write_b128 v200, v[156:159] offset:19456
    s_waitcnt lgkmcnt(0)
    s_mov_b64 exec, 1
    ds_add_u32 v254, v255 offset:16
    s_mov_b64 exec, -1
L_E2:
    ds_read_b32 v253, v254 offset:16
    s_sub_u32 s74, s74, 1
    s_cbranch_scc1 L_END
    s_waitcnt lgkmcnt(0)
    v_cmp_ne_u32 vcc, 4, v253
    s_cbranch_vccnz L_E2
    ds_read_b128 v[80:83], v201 offset:16384
    ds_read_b128 v[84:87], v201 offset:17408
    ds_read_b128 v[88:91], v201 offset:18432
    ds_read_b128 v[92:95], v201 offset:19456
    s_waitcnt lgkmcnt(3)
    v_mfma_f32_16x16x32_bf16 v[112:115], v[240:243], v[80:83], 0
    v_mfma_f32_16x16x32_bf16 v[116:119], v[244:247], v[80:83], 0
    s_waitcnt lgkmcnt(2)
    v_mfma_f32_16x16x32_bf16 v[120:123], v[240:243], v[84:87], 0
    v_mfma_f32_16x16x32_bf16 v[124:127], v[244:247], v[84:87], 0
    s_waitcnt lgkmcnt(1)
    v_mfma_f32_16x16x32_bf16 v[128:131], v[240:243], v[88:91], 0
    v_mfma_f32_16x16x32_bf16 v[132:135], v[244:247], v[88:91], 0
    s_waitcnt lgkmcnt(0)
    v_mfma_f32_16x16x32_bf16 v[136:139], v[240:243], v[92:95], 0
    v_mfma_f32_16x16x32_bf16 v[140:143], v[244:247], v[92:95], 0
    v_cvt_pk_bf16_f32 v144, v112, -v116
    v_or_b32 v144, 1, v144
    buffer_store_dword v144, v248, s[24:27], s20 offen offset:0 sc1
    v_cvt_pk_bf16_f32 v145, v113, -v117
    v_or_b32 v145, 1, v145
    buffer_store_dword v145, v248, s[24:27], s20 offen offset:256 sc1
    v_cvt_pk_bf16_f32 v146, v114, -v118
    v_or_b32 v146, 1, v146
    buffer_store_dword v146, v248, s[24:27], s20 offen offset:512 sc1
    v_cvt_pk_bf16_f32 v147, v115, -v119
    v_or_b32 v147, 1, v147
    buffer_store_dword v147, v248, s[24:27], s20 offen offset:768 sc1
    v_cvt_pk_bf16_f32 v148, v120, -v124
    v_or_b32 v148, 1, v148
    buffer_store_dword v148, v248, s[24:27], s20 offen offset:1024 sc1
    v_cvt_pk_bf16_f32 v149, v121, -v125
    v_or_b32 v149, 1, v149
    buffer_store_dword v149, v248, s[24:27], s20 offen offset:1280 sc1
    v_cvt_pk_bf16_f32 v150, v122, -v126
    v_or_b32 v150, 1, v150
    buffer_store_dword v150, v248, s[24:27], s20 offen offset:1536 sc1
    v_cvt_pk_bf16_f32 v151, v123, -v127
    v_or_b32 v151, 1, v151
    buffer_store_dword v151, v248, s[24:27], s20 offen offset:1792 sc1
    v_cvt_pk_bf16_f32 v152, v128, -v132
    v_or_b32 v152, 1, v152
    buffer_store_dword v152, v248, s[24:27], s20 offen offset:2048 sc1
    v_cvt_pk_bf16_f32 v153, v129, -v133
    v_or_b32 v153, 1, v153
    buffer_store_dword v153, v248, s[24:27], s20 offen offset:2304 sc1
    v_cvt_pk_bf16_f32 v154, v130, -v134
    v_or_b32 v154, 1, v154
    buffer_store_dword v154, v248, s[24:27], s20 offen offset:2560 sc1
    v_cvt_pk_bf16_f32 v155, v131, -v135
    v_or_b32 v155, 1, v155
    buffer_store_dword v155, v248, s[24:27], s20 offen offset:2816 sc1
    v_cvt_pk_bf16_f32 v156, v136, -v140
    v_or_b32 v156, 1, v156
    buffer_store_dword v156, v248, s[24:27], s20 offen offset:3072 sc1
    v_cvt_pk_bf16_f32 v157, v137, -v141
    v_or_b32 v157, 1, v157
    buffer_store_dword v157, v248, s[24:27], s20 offen offset:3328 sc1
    v_cvt_pk_bf16_f32 v158, v138, -v142
    v_or_b32 v158, 1, v158
    buffer_store_dword v158, v248, s[24:27], s20 offen offset:3584 sc1
    v_cvt_pk_bf16_f32 v159, v139, -v143
    v_or_b32 v159, 1, v159
    buffer_store_dword v159, v248, s[24:27], s20 offen offset:3840 sc1
L_NOB2:
    s_setprio 0
    s_lshl_b32 s61, s58, 19
    s_add_u32 s61, s61, s53
    s_add_u32 s68, s61, 0x40000
    s_add_u32 s63, s53, 2097152
    v_lshrrev_b32 v249, 2, v0
    v_lshlrev_b32 v249, 14, v249
    v_and_b32 v250, 3, v0
    v_lshl_add_u32 v249, v250, 4, v249
    v_add_u32 v250, s62, v7
    v_add_u32 v250, 147456, v250
    s_lshl_b32 s67, s58, 9
    s_add_u32 s67, s67, s2
    v_and_b32 v10, 1, v0
    v_lshlrev_b32 v10, 8, v10
    v_add_u32 v10, s67, v10
    v_cvt_f32_u32 v10, v10
    v_mul_f32 v10, 0x3a000000, v10
    v_lshrrev_b32 v11, 5, v0
    v_cvt_f32_u32 v11, v11
    v_cmp_eq_u32 vcc, 0, v15
    s_nop 1
    v_cndmask_b32 v196, 0, -1, vcc
    v_cmp_eq_u32 vcc, 1, v15
    s_nop 1
    v_cndmask_b32 v197, 0, -1, vcc
    v_cmp_eq_u32 vcc, 2, v15
    s_nop 1
    v_cndmask_b32 v198, 0, -1, vcc
    v_cmp_eq_u32 vcc, 3, v15
    s_nop 1
    v_cndmask_b32 v199, 0, -1, vcc
    v_mul_f32 v12, v11, v10
    v_mov_b32 v13, 0xc0400000
    v_fma_f32 v13, v13, v11, 4.0
    v_mul_f32 v13, v13, v10
    v_add_f32 v14, 2.0, v11
    v_mul_f32 v14, v14, v10
    v_cos_f32 v194, v12
    v_sin_f32 v195, v12
    v_mul_f32 v194, 0x36000000, v194
    v_mul_f32 v195, 0x36000000, v195
    v_cvt_pk_bf16_f32 v19, v194, -v195
    v_cvt_pk_bf16_f32 v23, v195, v194
    v_and_b32 v16, v19, v196
    v_and_b32 v17, v19, v197
    v_and_b32 v18, v19, v198
    v_and_b32 v19, v19, v199
    v_and_b32 v20, v23, v196
    v_and_b32 v21, v23, v197
    v_and_b32 v22, v23, v198
    v_and_b32 v23, v23, v199
    v_cos_f32 v194, v13
    v_sin_f32 v195, v13
    v_mul_f32 v194, 0x36000000, v194
    v_mul_f32 v195, 0x36000000, v195
    v_cvt_pk_bf16_f32 v27, v194, -v195
    v_cvt_pk_bf16_f32 v31, v195, v194
    v_and_b32 v24, v27, v196
    v_and_b32 v25, v27, v197
    v_and_b32 v26, v27, v198
    v_and_b32 v27, v27, v199
    v_and_b32 v28, v31, v196
    v_and_b32 v29, v31, v197
    v_and_b32 v30, v31, v198
    v_and_b32 v31, v31, v199
    v_cos_f32 v194, v14
    v_sin_f32 v195, v14
    v_mul_f32 v194, 0x36000000, v194
    v_mul_f32 v195, 0x36000000, v195
    v_cvt_pk_bf16_f32 v35, v194, -v195
    v_cvt_pk_bf16_f32 v39, v195, v194
    v_and_b32 v32, v35, v196
    v_and_b32 v33, v35, v197
    v_and_b32 v34, v35, v198
    v_and_b32 v35, v35, v199
    v_and_b32 v36, v39, v196
    v_and_b32 v37, v39, v197
    v_and_b32 v38, v39, v198
    v_and_b32 v39, v39, v199
    v_mul_f32 v12, 0x3d800000, v8
    v_mul_f32 v13, v9, v12
    v_mul_f32 v12, 4.0, v12
    v_cos_f32 v194, v13
    v_sin_f32 v195, v13
    v_add_f32 v13, v13, v12
    v_cvt_pk_bf16_f32 v40, v194, -v195
    v_cvt_pk_bf16_f32 v44, v195, v194
    v_cos_f32 v194, v13
    v_sin_f32 v195, v13
    v_add_f32 v13, v13, v12
    v_cvt_pk_bf16_f32 v41, v194, -v195
    v_cvt_pk_bf16_f32 v45, v195, v194
    v_cos_f32 v194, v13
    v_sin_f32 v195, v13
    v_add_f32 v13, v13, v12
    v_cvt_pk_bf16_f32 v42, v194, -v195
    v_cvt_pk_bf16_f32 v46, v195, v194
    v_cos_f32 v194, v13
    v_sin_f32 v195, v13
    s_nop 0
    v_cvt_pk_bf16_f32 v43, v194, -v195
    v_cvt_pk_bf16_f32 v47, v195, v194
    v_bfe_u32 v12, v0, 4, 1
    v_cvt_f32_u32 v12, v12
    v_add_f32 v12, v12, v12
    v_mov_b32 v13, 0x41800000
    v_fma_f32 v12, v11, v13, v12
    v_mul_f32 v13, 0x3b000000, v8
    v_mul_f32 v14, v12, v13
    v_mul_f32 v15, 0x40400000, v13
    v_cos_f32 v48, v14
    v_sin_f32 v56, v14
    v_mul_f32 v12, 0x41800000, v14
    v_cos_f32 v194, v12
    v_sin_f32 v195, v12
    v_add_f32 v14, v14, v13
    v_cvt_pk_bf16_f32 v64, v194, -v195
    v_cvt_pk_bf16_f32 v68, v194, -v195
    v_cos_f32 v49, v14
    v_sin_f32 v57, v14
    v_mul_f32 v12, 0x41800000, v14
    v_cos_f32 v194, v12
    v_sin_f32 v195, v12
    v_add_f32 v14, v14, v15
    v_cvt_pk_bf16_f32 v65, v194, -v195
    v_cvt_pk_bf16_f32 v69, -v194, v195
    v_cos_f32 v50, v14
    v_sin_f32 v58, v14
    v_mul_f32 v12, 0x41800000, v14
    v_cos_f32 v194, v12
    v_sin_f32 v195, v12
    v_add_f32 v14, v14, v13
    v_cvt_pk_bf16_f32 v66, v194, -v195
    v_cvt_pk_bf16_f32 v70, v194, -v195
    v_cos_f32 v51, v14
    v_sin_f32 v59, v14
    v_mul_f32 v12, 0x41800000, v14
    v_cos_f32 v194, v12
    v_sin_f32 v195, v12
    v_add_f32 v14, v14, v15
    v_cvt_pk_bf16_f32 v67, v194, -v195
    v_cvt_pk_bf16_f32 v71, -v194, v195
    v_cos_f32 v52, v14
    v_sin_f32 v60, v14
    v_mul_f32 v12, 0x41800000, v14
    v_cos_f32 v194, v12
    v_sin_f32 v195, v12
    v_add_f32 v14, v14, v13
    v_cvt_pk_bf16_f32 v72, v194, -v195
    v_cvt_pk_bf16_f32 v76, v194, -v195
    v_cos_f32 v53, v14
    v_sin_f32 v61, v14
    v_mul_f32 v12, 0x41800000, v14
    v_cos_f32 v194, v12
    v_sin_f32 v195, v12
    v_add_f32 v14, v14, v15
    v_cvt_pk_bf16_f32 v73, v194, -v195
    v_cvt_pk_bf16_f32 v77, -v194, v195
    v_cos_f32 v54, v14
    v_sin_f32 v62, v14
    v_mul_f32 v12, 0x41800000, v14
    v_cos_f32 v194, v12
    v_sin_f32 v195, v12
    v_add_f32 v14, v14, v13
    v_cvt_pk_bf16_f32 v74, v194, -v195
    v_cvt_pk_bf16_f32 v78, v194, -v195
    v_cos_f32 v55, v14
    v_sin_f32 v63, v14
    v_mul_f32 v12, 0x41800000, v14
    v_cos_f32 v194, v12
    v_sin_f32 v195, v12
    s_nop 0
    v_cvt_pk_bf16_f32 v75, v194, -v195
    v_cvt_pk_bf16_f32 v79, -v194, v195
    v_cvt_f32_u32 v12, s2
    v_mul_f32 v12, 0x3b000000, v12
    v_cos_f32 v13, v12
    v_sin_f32 v14, v12
    v_lshlrev_b32 v10, 10, v3
    v_lshl_add_u32 v10, v2, 4, v10
    v_mul_f32 v13, 0x35800000, v13
    v_mul_f32 v14, 0x35800000, v14
    v_lshlrev_b32 v11, 5, v2
    v_lshl_add_u32 v11, v3, 3, v11
    v_mov_b32 v15, 0
    s_lshl_b32 s65, s67, 11
    s_add_u32 s65, s65, 1024
    s_add_u32 s66, s65, 0x80000
    v_add_u32 v10, 147456, v10
    s_setprio 3
L_H2G:
    s_sleep 1
    ds_read_b32 v253, v254 offset:52
    s_sub_u32 s74, s74, 1
    s_cbranch_scc1 L_END
    s_waitcnt lgkmcnt(0)
    v_cmp_ne_u32 vcc, 4, v253
    s_cbranch_vccnz L_H2G
L_UL:
    buffer_load_dwordx4 v[112:115], v249, s[24:27], s61 offen sc1
    buffer_load_dwordx4 v[116:119], v249, s[24:27], s68 offen sc1
    buffer_load_dword v9, v15, s[24:27], s63 offen sc1
    buffer_load_dword v8, v15, s[24:27], s63 offen offset:32 sc1
    s_waitcnt vmcnt(3)
    ds_write_b128 v250, v[112:115]
    v_and_b32 v1, v112, v113
    v_and_b32 v12, v114, v115
    s_waitcnt vmcnt(2)
    ds_write_b128 v250, v[116:119] offset:1024
    v_and_b32 v1, v1, v116
    v_and_b32 v12, v12, v117
    v_and_b32 v1, v1, v118
    v_and_b32 v12, v12, v119
    s_waitcnt vmcnt(0)
    v_and_b32 v1, v1, v8
    v_and_b32 v12, v12, v9
    v_and_b32 v1, v1, v12
    v_and_b32 v1, 1, v1
    v_cmp_eq_u32 vcc, 0, v1
    s_cbranch_vccnz L_URE
    s_waitcnt lgkmcnt(0)
    s_mov_b64 exec, 1
    ds_add_u32 v254, v255 offset:68
    s_mov_b64 exec, -1
L_UW:
    ds_read_b32 v253, v254 offset:68
    s_sub_u32 s74, s74, 1
    s_cbranch_scc1 L_END
    s_waitcnt lgkmcnt(0)
    v_cmp_ne_u32 vcc, 4, v253
    s_cbranch_vccnz L_UW
    ds_read_b128 v[80:83], v10 offset:0
    ds_read_b128 v[84:87], v10 offset:4096
    ds_read_b128 v[88:91], v10 offset:256
    ds_read_b128 v[92:95], v10 offset:4352
    ds_read_b128 v[96:99], v10 offset:512
    ds_read_b128 v[100:103], v10 offset:4608
    ds_read_b128 v[104:107], v10 offset:768
    ds_read_b128 v[108:111], v10 offset:4864
    s_waitcnt lgkmcnt(7)
    v_mfma_f32_16x16x32_bf16 v[112:115], v[80:83], v[16:19], 0
    v_lshlrev_b32 v8, 16, v8
    v_mfma_f32_16x16x32_bf16 v[116:119], v[80:83], v[20:23], 0
    v_and_b32 v12, 0xffff0000, v9
    s_waitcnt lgkmcnt(6)
    v_mfma_f32_16x16x32_bf16 v[112:115], v[84:87], v[32:35], v[112:115]
    v_lshlrev_b32 v9, 16, v9
    v_mfma_f32_16x16x32_bf16 v[116:119], v[84:87], v[36:39], v[116:119]
    v_mul_f32 v8, 0x35800000, v8
    s_waitcnt lgkmcnt(5)
    v_mfma_f32_16x16x32_bf16 v[120:123], v[88:91], v[16:19], 0
    v_mul_f32 v9, v9, v13
    v_mfma_f32_16x16x32_bf16 v[124:127], v[88:91], v[20:23], 0
    v_fma_f32 v9, -v12, v14, v9
    s_waitcnt lgkmcnt(4)
    v_mfma_f32_16x16x32_bf16 v[120:123], v[92:95], v[32:35], v[120:123]
    v_add_f32 v192, v9, v8
    v_mfma_f32_16x16x32_bf16 v[124:127], v[92:95], v[36:39], v[124:127]
    v_sub_f32 v193, v9, v8
    s_waitcnt lgkmcnt(3)
    v_mfma_f32_16x16x32_bf16 v[128:131], v[96:99], v[24:27], 0
    v_cvt_pk_bf16_f32 v144, v112, v116
    v_mfma_f32_16x16x32_bf16 v[132:135], v[96:99], v[28:31], 0
    v_cvt_pk_bf16_f32 v148, v113, v117
    s_waitcnt lgkmcnt(2)
    v_mfma_f32_16x16x32_bf16 v[128:131], v[100:103], v[32:35], v[128:131]
    v_cvt_pk_bf16_f32 v152, v114, v118
    v_mfma_f32_16x16x32_bf16 v[132:135], v[100:103], v[36:39], v[132:135]
    v_cvt_pk_bf16_f32 v156, v115, v119
    s_waitcnt lgkmcnt(1)
    v_mfma_f32_16x16x32_bf16 v[136:139], v[104:107], v[24:27], 0
    v_cvt_pk_bf16_f32 v145, v120, v124
    v_mfma_f32_16x16x32_bf16 v[140:143], v[104:107], v[28:31], 0
    v_cvt_pk_bf16_f32 v149, v121, v125
    s_waitcnt lgkmcnt(0)
    v_mfma_f32_16x16x32_bf16 v[136:139], v[108:111], v[32:35], v[136:139]
    v_cvt_pk_bf16_f32 v153, v122, v126
    v_mfma_f32_16x16x32_bf16 v[140:143], v[108:111], v[36:39], v[140:143]
    v_cvt_pk_bf16_f32 v157, v123, v127
    v_cvt_pk_bf16_f32 v146, v128, v132
    v_cvt_pk_bf16_f32 v150, v129, v133
    v_cvt_pk_bf16_f32 v154, v130, v134
    v_cvt_pk_bf16_f32 v158, v131, v135
    v_add_f32 v194, v9, v8
    v_sub_f32 v195, v9, v8
    v_sub_f32 v196, v8, v9
    v_sub_f32 v197, -v9, v8
    v_sub_f32 v198, v8, v9
    v_sub_f32 v199, -v9, v8
    v_cvt_pk_bf16_f32 v147, v136, v140
    v_cvt_pk_bf16_f32 v151, v137, v141
    v_cvt_pk_bf16_f32 v155, v138, v142
    v_cvt_pk_bf16_f32 v159, v139, v143
    v_mfma_f32_16x16x32_bf16 v[160:163], v[144:147], v[40:43], 0
    v_mfma_f32_16x16x32_bf16 v[164:167], v[144:147], v[44:47], 0
    v_mfma_f32_16x16x32_bf16 v[168:171], v[148:151], v[40:43], 0
    v_mfma_f32_16x16x32_bf16 v[172:175], v[148:151], v[44:47], 0
    v_mfma_f32_16x16x32_bf16 v[176:179], v[152:155], v[40:43], 0
    v_mfma_f32_16x16x32_bf16 v[180:183], v[152:155], v[44:47], 0
    v_mfma_f32_16x16x32_bf16 v[184:187], v[156:159], v[40:43], 0
    v_mfma_f32_16x16x32_bf16 v[188:191], v[156:159], v[44:47], 0
    s_nop 0
    v_pk_mul_f32 v[80:81], v[160:161], v[48:49] op_sel_hi:[1,0]
    v_pk_mul_f32 v[84:85], v[164:165], v[48:49] op_sel_hi:[1,0]
    v_pk_mul_f32 v[82:83], v[162:163], v[48:49] op_sel:[0,1] op_sel_hi:[1,1]
    v_pk_mul_f32 v[86:87], v[166:167], v[48:49] op_sel:[0,1] op_sel_hi:[1,1]
    v_pk_fma_f32 v[80:81], v[164:165], v[56:57], v[80:81] op_sel_hi:[1,0,1] neg_lo:[1,0,0] neg_hi:[1,0,0]
    v_pk_fma_f32 v[84:85], v[160:161], v[56:57], v[84:85] op_sel_hi:[1,0,1]
    v_pk_fma_f32 v[82:83], v[166:167], v[56:57], v[82:83] op_sel:[0,1,0] op_sel_hi:[1,1,1] neg_lo:[1,0,0] neg_hi:[1,0,0]
    v_pk_fma_f32 v[86:87], v[162:163], v[56:57], v[86:87] op_sel:[0,1,0] op_sel_hi:[1,1,1]
    v_cvt_pk_bf16_f32 v112, v80, v84
    v_cvt_pk_bf16_f32 v113, v82, v86
    v_cvt_pk_bf16_f32 v120, v81, v85
    v_cvt_pk_bf16_f32 v121, v83, v87
    v_pk_mul_f32 v[88:89], v[168:169], v[50:51] op_sel_hi:[1,0]
    v_pk_mul_f32 v[92:93], v[172:173], v[50:51] op_sel_hi:[1,0]
    v_pk_mul_f32 v[90:91], v[170:171], v[50:51] op_sel:[0,1] op_sel_hi:[1,1]
    v_pk_mul_f32 v[94:95], v[174:175], v[50:51] op_sel:[0,1] op_sel_hi:[1,1]
    v_pk_fma_f32 v[88:89], v[172:173], v[58:59], v[88:89] op_sel_hi:[1,0,1] neg_lo:[1,0,0] neg_hi:[1,0,0]
    v_pk_fma_f32 v[92:93], v[168:169], v[58:59], v[92:93] op_sel_hi:[1,0,1]
    v_pk_fma_f32 v[90:91], v[174:175], v[58:59], v[90:91] op_sel:[0,1,0] op_sel_hi:[1,1,1] neg_lo:[1,0,0] neg_hi:[1,0,0]
    v_pk_fma_f32 v[94:95], v[170:171], v[58:59], v[94:95] op_sel:[0,1,0] op_sel_hi:[1,1,1]
    v_cvt_pk_bf16_f32 v114, v88, v92
    v_cvt_pk_bf16_f32 v115, v90, v94
    v_cvt_pk_bf16_f32 v122, v89, v93
    v_cvt_pk_bf16_f32 v123, v91, v95
    v_pk_mul_f32 v[80:81], v[176:177], v[52:53] op_sel_hi:[1,0]
    v_pk_mul_f32 v[84:85], v[180:181], v[52:53] op_sel_hi:[1,0]
    v_pk_mul_f32 v[82:83], v[178:179], v[52:53] op_sel:[0,1] op_sel_hi:[1,1]
    v_pk_mul_f32 v[86:87], v[182:183], v[52:53] op_sel:[0,1] op_sel_hi:[1,1]
    v_pk_fma_f32 v[80:81], v[180:181], v[60:61], v[80:81] op_sel_hi:[1,0,1] neg_lo:[1,0,0] neg_hi:[1,0,0]
    v_pk_fma_f32 v[84:85], v[176:177], v[60:61], v[84:85] op_sel_hi:[1,0,1]
    v_pk_fma_f32 v[82:83], v[182:183], v[60:61], v[82:83] op_sel:[0,1,0] op_sel_hi:[1,1,1] neg_lo:[1,0,0] neg_hi:[1,0,0]
    v_pk_fma_f32 v[86:87], v[178:179], v[60:61], v[86:87] op_sel:[0,1,0] op_sel_hi:[1,1,1]
    v_cvt_pk_bf16_f32 v116, v80, v84
    v_cvt_pk_bf16_f32 v117, v82, v86
    v_cvt_pk_bf16_f32 v124, v81, v85
    v_cvt_pk_bf16_f32 v125, v83, v87
    v_pk_mul_f32 v[88:89], v[184:185], v[54:55] op_sel_hi:[1,0]
    v_pk_mul_f32 v[92:93], v[188:189], v[54:55] op_sel_hi:[1,0]
    v_pk_mul_f32 v[90:91], v[186:187], v[54:55] op_sel:[0,1] op_sel_hi:[1,1]
    v_pk_mul_f32 v[94:95], v[190:191], v[54:55] op_sel:[0,1] op_sel_hi:[1,1]
    v_pk_fma_f32 v[88:89], v[188:189], v[62:63], v[88:89] op_sel_hi:[1,0,1] neg_lo:[1,0,0] neg_hi:[1,0,0]
    v_pk_fma_f32 v[92:93], v[184:185], v[62:63], v[92:93] op_sel_hi:[1,0,1]
    v_pk_fma_f32 v[90:91], v[190:191], v[62:63], v[90:91] op_sel:[0,1,0] op_sel_hi:[1,1,1] neg_lo:[1,0,0] neg_hi:[1,0,0]
    v_pk_fma_f32 v[94:95], v[186:187], v[62:63], v[94:95] op_sel:[0,1,0] op_sel_hi:[1,1,1]
    v_cvt_pk_bf16_f32 v118, v88, v92
    v_cvt_pk_bf16_f32 v119, v90, v94
    v_cvt_pk_bf16_f32 v126, v89, v93
    v_cvt_pk_bf16_f32 v127, v91, v95
    v_mfma_f32_16x16x32_bf16 v[128:131], v[112:115], v[64:67], v[192:195]
    v_mfma_f32_16x16x32_bf16 v[132:135], v[112:115], v[68:71], v[192:195]
    v_mfma_f32_16x16x32_bf16 v[136:139], v[120:123], v[64:67], v[196:199]
    v_mfma_f32_16x16x32_bf16 v[140:143], v[120:123], v[68:71], v[196:199]
    v_mfma_f32_16x16x32_bf16 v[128:131], v[116:119], v[72:75], v[128:131]
    v_mfma_f32_16x16x32_bf16 v[132:135], v[116:119], v[76:79], v[132:135]
    v_mfma_f32_16x16x32_bf16 v[136:139], v[124:127], v[72:75], v[136:139]
    v_mfma_f32_16x16x32_bf16 v[140:143], v[124:127], v[76:79], v[140:143]
    s_nop 4
    v_cvt_pk_bf16_f32 v144, v128, v129
    v_cvt_pk_bf16_f32 v145, v130, v131
    buffer_store_dwordx2 v[144:145], v11, s[40:43], s65 offen offset:0
    v_cvt_pk_bf16_f32 v146, v132, v133
    v_cvt_pk_bf16_f32 v147, v134, v135
    buffer_store_dwordx2 v[146:147], v11, s[40:43], s65 offen offset:512
    v_cvt_pk_bf16_f32 v148, v136, v137
    v_cvt_pk_bf16_f32 v149, v138, v139
    buffer_store_dwordx2 v[148:149], v11, s[40:43], s66 offen offset:0
    v_cvt_pk_bf16_f32 v150, v140, v141
    v_cvt_pk_bf16_f32 v151, v142, v143
    buffer_store_dwordx2 v[150:151], v11, s[40:43], s66 offen offset:512
    s_endpgm
C_MAIN:
    s_setprio 2
    s_add_u32 s24, s20, 0
    s_addc_u32 s25, s21, 0
    s_mov_b64 s[40:41], s[16:17]
    s_mov_b64 s[44:45], s[18:19]
    s_mov_b32 s26, 10485760
    s_mov_b32 s27, 0x20000
    s_mov_b32 s42, 4194304
    s_mov_b32 s43, 0x20000
    s_mov_b32 s46, 256
    s_mov_b32 s47, 0x20000
    s_mov_b32 s72, 262144
    s_mov_b32 s74, 4194304
    v_mov_b32 v254, 163584
    v_mov_b32 v255, 1
    v_and_b32 v2, 15, v0
    v_lshrrev_b32 v3, 4, v0
    v_cvt_f32_u32 v8, v2
    v_cvt_f32_u32 v9, v3
    v_lshrrev_b32 v12, 1, v0
    v_lshrrev_b32 v13, 2, v0
    v_and_b32 v13, 4, v13
    v_xor_b32 v12, v12, v13
    v_and_b32 v15, 7, v12
    s_and_b32 s57, s49, 3
    s_lshl2_add_u32 s54, s48, s57
    s_lshr_b32 s55, s49, 2
    s_lshl1_add_u32 s57, s57, s55
    s_and_b32 s19, s2, 15
    s_lshl_b32 s19, s19, 7
    s_add_u32 s19, s19, 7667712
    s_lshl_b32 s60, s3, 8
    s_mul_i32 s61, s2, s3
    s_add_u32 s59, s61, 512
    s_cmp_eq_u32 s3, 0
    s_cselect_b32 s62, 1024, s60
    s_cselect_b32 s59, 0, s59
    s_cselect_b32 s58, s2, 0
    s_cselect_b32 s65, 0, 0xbe800000
    s_cselect_b64 s[66:67], -1, 0
    v_and_b32 v14, 1, v0
    v_cmp_eq_u32 vcc, 1, v14
    v_mov_b32 v4, 0xffff
    v_mov_b32 v5, 0xffff0000
    v_cndmask_b32 v14, v4, v5, vcc
    v_cmp_eq_u32 vcc, 0, v15
    s_nop 1
    v_cndmask_b32 v228, 0, v14, vcc
    v_cmp_eq_u32 vcc, 1, v15
    s_nop 1
    v_cndmask_b32 v229, 0, v14, vcc
    v_cmp_eq_u32 vcc, 2, v15
    s_nop 1
    v_cndmask_b32 v230, 0, v14, vcc
    v_cmp_eq_u32 vcc, 3, v15
    s_nop 1
    v_cndmask_b32 v231, 0, v14, vcc
    v_lshrrev_b32 v10, 5, v0
    v_mov_b32 v11, s61
    v_mov_b32 v12, s59
    v_mad_u32_u24 v11, v10, s60, v11
    v_mad_u32_u24 v12, v10, s62, v12
    v_cvt_f32_u32 v11, v11
    v_cvt_f32_u32 v12, v12
    v_cvt_f32_u32 v13, s60
    v_cvt_f32_u32 v14, s62
    v_mul_f32 v11, 0x3a000000, v11
    v_mul_f32 v12, 0x3a000000, v12
    v_mul_f32 v13, 0x3a800000, v13
    v_mul_f32 v14, 0x3a800000, v14
    v_cos_f32 v19, v11
    v_add_f32 v11, v11, v13
    v_cvt_pk_bf16_f32 v19, v19, v19
    v_and_b32 v16, v19, v228
    v_and_b32 v17, v19, v229
    v_and_b32 v18, v19, v230
    v_and_b32 v19, v19, v231
    v_cos_f32 v23, v12
    v_add_f32 v12, v12, v14
    v_cvt_pk_bf16_f32 v23, v23, v23
    v_and_b32 v20, v23, v228
    v_and_b32 v21, v23, v229
    v_and_b32 v22, v23, v230
    v_and_b32 v23, v23, v231
    v_cos_f32 v27, v11
    v_add_f32 v11, v11, v13
    v_cvt_pk_bf16_f32 v27, v27, v27
    v_and_b32 v24, v27, v228
    v_and_b32 v25, v27, v229
    v_and_b32 v26, v27, v230
    v_and_b32 v27, v27, v231
    v_cos_f32 v31, v12
    v_add_f32 v12, v12, v14
    v_cvt_pk_bf16_f32 v31, v31, v31
    v_and_b32 v28, v31, v228
    v_and_b32 v29, v31, v229
    v_and_b32 v30, v31, v230
    v_and_b32 v31, v31, v231
    v_cos_f32 v35, v11
    v_add_f32 v11, v11, v13
    v_cvt_pk_bf16_f32 v35, v35, v35
    v_and_b32 v32, v35, v228
    v_and_b32 v33, v35, v229
    v_and_b32 v34, v35, v230
    v_and_b32 v35, v35, v231
    v_cos_f32 v39, v12
    v_add_f32 v12, v12, v14
    v_cvt_pk_bf16_f32 v39, v39, v39
    v_and_b32 v36, v39, v228
    v_and_b32 v37, v39, v229
    v_and_b32 v38, v39, v230
    v_and_b32 v39, v39, v231
    v_cos_f32 v43, v11
    s_nop 0
    v_cvt_pk_bf16_f32 v43, v43, v43
    v_and_b32 v40, v43, v228
    v_and_b32 v41, v43, v229
    v_and_b32 v42, v43, v230
    v_and_b32 v43, v43, v231
    v_cos_f32 v47, v12
    s_nop 0
    v_cvt_pk_bf16_f32 v47, v47, v47
    v_and_b32 v44, v47, v228
    v_and_b32 v45, v47, v229
    v_and_b32 v46, v47, v230
    v_and_b32 v47, v47, v231
    v_mul_f32 v10, 0x3d000000, v8
    v_mul_f32 v11, 4.0, v9
    v_mul_f32 v12, v11, v10
    v_cos_f32 v128, v12
    v_sin_f32 v132, v12
    v_add_f32 v12, v12, v10
    v_cos_f32 v129, v12
    v_sin_f32 v133, v12
    v_add_f32 v12, v12, v10
    v_cos_f32 v130, v12
    v_sin_f32 v134, v12
    v_add_f32 v12, v12, v10
    v_cos_f32 v131, v12
    v_sin_f32 v135, v12
    v_lshlrev_b32 v13, 31, v0
    v_lshrrev_b32 v14, 16, v13
    v_or_b32 v13, v13, v14
    v_cvt_pk_bf16_f32 v48, v128, v129
    v_cvt_pk_bf16_f32 v49, v130, v131
    v_cvt_pk_bf16_f32 v52, -v132, -v133
    v_cvt_pk_bf16_f32 v53, -v134, -v135
    s_brev_b32 s68, 1
    v_xor_b32 v50, v48, v13
    v_xor_b32 v51, v49, v13
    v_xor_b32 v56, s68, v48
    v_xor_b32 v57, s68, v49
    v_xor_b32 v58, s68, v50
    v_xor_b32 v59, s68, v51
    v_xor_b32 v54, v52, v13
    v_xor_b32 v55, v53, v13
    v_xor_b32 v60, s68, v52
    v_xor_b32 v61, s68, v53
    v_xor_b32 v62, s68, v54
    v_xor_b32 v63, s68, v55
    v_cmp_gt_u32 vcc, 8, v2
    s_nop 0
    s_andn2_b64 s[22:23], s[66:67], vcc
    s_and_b64 s[66:67], s[66:67], vcc
    v_cndmask_b32 v212, -1, 0, s[22:23]
    v_cndmask_b32 v213, -1, 0, s[66:67]
    v_lshrrev_b32 v214, 5, v0
    v_lshlrev_b32 v214, 10, v214
    v_lshl_add_u32 v214, v2, 5, v214
    v_and_b32 v12, 16, v0
    v_add_u32 v214, v214, v12
    v_add_u32 v214, 131072, v214
    s_cmp_lt_u32 s52, 82
    s_cbranch_scc0 C_NOGO
    s_and_b32 s22, s52, 1
    s_lshl_b32 s22, s22, 7
    s_mov_b64 exec, 1
    s_waitcnt vmcnt(2)
    buffer_atomic_add v255, v7, s[44:47], s22 offen sc1
    s_mov_b64 exec, -1
    s_waitcnt vmcnt(1)
    s_branch C_BXOK
C_NOGO:
    s_waitcnt vmcnt(0)
C_BXOK:
    s_mov_b64 exec, 1
    ds_add_u32 v254, v255 offset:0
    s_mov_b64 exec, -1
    v_cvt_f32_u32 v14, s58
    v_mul_f32 v14, 0x3b000000, v14
    v_mul_f32 v13, 0x3b000000, v8
    v_mul_f32 v12, v11, v13
    v_cos_f32 v64, v12
    v_sin_f32 v80, v12
    v_add_f32 v15, v12, v14
    v_cos_f32 v72, v15
    v_sin_f32 v88, v15
    v_add_f32 v12, v12, v13
    v_cos_f32 v65, v12
    v_sin_f32 v81, v12
C_BXW:
    ds_read_b32 v253, v254 offset:0
    s_sub_u32 s74, s74, 1
    s_cbranch_scc1 L_END
    s_waitcnt lgkmcnt(0)
    v_cmp_ne_u32 vcc, 4, v253
    s_cbranch_vccnz C_BXW
    ds_read_b128 v[112:115], v214 offset:0
    ds_read_b128 v[116:119], v214 offset:2048
    ds_read_b128 v[120:123], v214 offset:4096
    ds_read_b128 v[124:127], v214 offset:6144
    ds_read_b128 v[128:131], v214 offset:512
    ds_read_b128 v[132:135], v214 offset:2560
    ds_read_b128 v[136:139], v214 offset:4608
    ds_read_b128 v[140:143], v214 offset:6656
    v_add_f32 v15, v12, v14
    v_cos_f32 v73, v15
    v_sin_f32 v89, v15
    v_add_f32 v12, v12, v13
    v_cos_f32 v66, v12
    v_sin_f32 v82, v12
    v_add_f32 v15, v12, v14
    v_cos_f32 v74, v15
    s_waitcnt lgkmcnt(7)
    v_mfma_f32_16x16x32_bf16 v[144:147], v[112:115], v[16:19], 0
    v_sin_f32 v90, v15
    v_add_f32 v12, v12, v13
    v_cos_f32 v67, v12
    v_mfma_f32_16x16x32_bf16 v[148:151], v[112:115], v[20:23], 0
    v_sin_f32 v83, v12
    v_add_f32 v15, v12, v14
    v_cos_f32 v75, v15
    s_waitcnt lgkmcnt(6)
    v_mfma_f32_16x16x32_bf16 v[144:147], v[116:119], v[24:27], v[144:147]
    v_sin_f32 v91, v15
    v_mul_f32 v13, 0x3b000000, v8
    v_add_f32 v13, 0x3d000000, v13
    v_mfma_f32_16x16x32_bf16 v[148:151], v[116:119], v[28:31], v[148:151]
    v_mul_f32 v12, v11, v13
    v_cos_f32 v68, v12
    v_sin_f32 v84, v12
    s_waitcnt lgkmcnt(5)
    v_mfma_f32_16x16x32_bf16 v[144:147], v[120:123], v[32:35], v[144:147]
    v_add_f32 v15, v12, v14
    v_cos_f32 v76, v15
    v_sin_f32 v92, v15
    v_mfma_f32_16x16x32_bf16 v[148:151], v[120:123], v[36:39], v[148:151]
    v_add_f32 v12, v12, v13
    v_cos_f32 v69, v12
    v_sin_f32 v85, v12
    s_waitcnt lgkmcnt(4)
    v_mfma_f32_16x16x32_bf16 v[144:147], v[124:127], v[40:43], v[144:147]
    v_add_f32 v15, v12, v14
    v_cos_f32 v77, v15
    v_sin_f32 v93, v15
    v_mfma_f32_16x16x32_bf16 v[148:151], v[124:127], v[44:47], v[148:151]
    v_add_f32 v12, v12, v13
    v_cos_f32 v70, v12
    v_sin_f32 v86, v12
    s_waitcnt lgkmcnt(3)
    v_mfma_f32_16x16x32_bf16 v[152:155], v[128:131], v[16:19], 0
    v_add_f32 v15, v12, v14
    v_cos_f32 v78, v15
    v_sin_f32 v94, v15
    v_mfma_f32_16x16x32_bf16 v[156:159], v[128:131], v[20:23], 0
    v_add_f32 v12, v12, v13
    v_cos_f32 v71, v12
    v_sin_f32 v87, v12
    s_waitcnt lgkmcnt(2)
    v_mfma_f32_16x16x32_bf16 v[152:155], v[132:135], v[24:27], v[152:155]
    v_add_f32 v15, v12, v14
    v_cos_f32 v79, v15
    v_sin_f32 v95, v15
    v_mfma_f32_16x16x32_bf16 v[156:159], v[132:135], v[28:31], v[156:159]
    v_add_f32 v10, v10, v10
    v_mul_f32 v12, v11, v10
    v_cos_f32 v208, v12
    s_waitcnt lgkmcnt(1)
    v_mfma_f32_16x16x32_bf16 v[152:155], v[136:139], v[32:35], v[152:155]
    v_sin_f32 v209, v12
    v_add_f32 v15, s65, v12
    v_cos_f32 v210, v15
    v_mfma_f32_16x16x32_bf16 v[156:159], v[136:139], v[36:39], v[156:159]
    v_sin_f32 v211, v15
    v_add_f32 v12, v12, v10
    v_cvt_pk_bf16_f32 v96, v208, v209
    s_waitcnt lgkmcnt(0)
    v_mfma_f32_16x16x32_bf16 v[152:155], v[140:143], v[40:43], v[152:155]
    v_cvt_pk_bf16_f32 v100, -v209, v208
    v_cvt_pk_bf16_f32 v104, v210, v211
    v_cvt_pk_bf16_f32 v108, -v211, v210
    v_mfma_f32_16x16x32_bf16 v[156:159], v[140:143], v[44:47], v[156:159]
    v_cos_f32 v208, v12
    v_sin_f32 v209, v12
    v_add_f32 v15, s65, v12
    v_cos_f32 v210, v15
    v_sin_f32 v211, v15
    v_add_f32 v12, v12, v10
    v_cvt_pk_bf16_f32 v97, v208, v209
    v_cvt_pk_bf16_f32 v101, -v209, v208
    v_cvt_pk_bf16_f32 v105, v210, v211
    v_cvt_pk_bf16_f32 v160, v144, v145
    v_cvt_pk_bf16_f32 v161, v146, v147
    v_cvt_pk_bf16_f32 v164, v148, v149
    v_cvt_pk_bf16_f32 v165, v150, v151
    v_cvt_pk_bf16_f32 v162, v152, v153
    v_cvt_pk_bf16_f32 v163, v154, v155
    v_cvt_pk_bf16_f32 v166, v156, v157
    v_cvt_pk_bf16_f32 v167, v158, v159
    v_mfma_f32_16x16x32_bf16 v[168:171], v[160:163], v[48:51], 0
    v_cvt_pk_bf16_f32 v109, -v211, v210
    v_cos_f32 v208, v12
    v_sin_f32 v209, v12
    v_mfma_f32_16x16x32_bf16 v[172:175], v[160:163], v[52:55], 0
    v_add_f32 v15, s65, v12
    v_cos_f32 v210, v15
    v_sin_f32 v211, v15
    v_mfma_f32_16x16x32_bf16 v[176:179], v[160:163], v[56:59], 0
    v_add_f32 v12, v12, v10
    v_cvt_pk_bf16_f32 v98, v208, v209
    v_cvt_pk_bf16_f32 v102, -v209, v208
    v_mfma_f32_16x16x32_bf16 v[180:183], v[160:163], v[60:63], 0
    v_cvt_pk_bf16_f32 v106, v210, v211
    v_cvt_pk_bf16_f32 v110, -v211, v210
    v_cos_f32 v208, v12
    v_mfma_f32_16x16x32_bf16 v[184:187], v[164:167], v[48:51], 0
    v_sin_f32 v209, v12
    v_add_f32 v15, s65, v12
    v_cos_f32 v210, v15
    v_mfma_f32_16x16x32_bf16 v[188:191], v[164:167], v[52:55], 0
    v_sin_f32 v211, v15
    v_cvt_pk_bf16_f32 v99, v208, v209
    v_cvt_pk_bf16_f32 v103, -v209, v208
    v_mfma_f32_16x16x32_bf16 v[192:195], v[164:167], v[56:59], 0
    v_cvt_pk_bf16_f32 v107, v210, v211
    v_cvt_pk_bf16_f32 v111, -v211, v210
    v_and_b32 v96, v96, v212
    v_mfma_f32_16x16x32_bf16 v[196:199], v[164:167], v[60:63], 0
    v_and_b32 v104, v104, v213
    v_and_b32 v97, v97, v212
    v_and_b32 v105, v105, v213
    v_and_b32 v98, v98, v212
    v_and_b32 v106, v106, v213
    v_and_b32 v99, v99, v212
    v_and_b32 v107, v107, v213
    v_and_b32 v100, v100, v212
    v_and_b32 v108, v108, v213
    v_and_b32 v101, v101, v212
    v_and_b32 v109, v109, v213
    v_and_b32 v102, v102, v212
    v_and_b32 v110, v110, v213
    v_and_b32 v103, v103, v212
    v_and_b32 v111, v111, v213
    v_pk_mul_f32 v[128:129], v[168:169], v[64:65]
    v_pk_mul_f32 v[132:133], v[172:173], v[64:65]
    v_pk_mul_f32 v[130:131], v[170:171], v[66:67]
    v_pk_mul_f32 v[134:135], v[174:175], v[66:67]
    v_pk_fma_f32 v[128:129], v[172:173], v[80:81], v[128:129]
    v_pk_fma_f32 v[132:133], v[168:169], v[80:81], v[132:133] neg_lo:[1,0,0] neg_hi:[1,0,0]
    v_pk_fma_f32 v[130:131], v[174:175], v[82:83], v[130:131]
    v_pk_fma_f32 v[134:135], v[170:171], v[82:83], v[134:135] neg_lo:[1,0,0] neg_hi:[1,0,0]
    v_cvt_pk_bf16_f32 v112, v128, v132
    v_cvt_pk_bf16_f32 v113, v129, v133
    v_cvt_pk_bf16_f32 v114, v130, v134
    v_cvt_pk_bf16_f32 v115, v131, v135
    v_pk_mul_f32 v[136:137], v[176:177], v[68:69]
    v_pk_mul_f32 v[140:141], v[180:181], v[68:69]
    v_pk_mul_f32 v[138:139], v[178:179], v[70:71]
    v_pk_mul_f32 v[142:143], v[182:183], v[70:71]
    v_mfma_f32_16x16x32_bf16 v[144:147], v[96:99], v[112:115], 0
    v_mfma_f32_16x16x32_bf16 v[148:151], v[100:103], v[112:115], 0
    v_mfma_f32_16x16x32_bf16 v[160:163], v[104:107], v[112:115], 0
    v_mfma_f32_16x16x32_bf16 v[164:167], v[108:111], v[112:115], 0
    v_pk_fma_f32 v[136:137], v[180:181], v[84:85], v[136:137]
    v_pk_fma_f32 v[140:141], v[176:177], v[84:85], v[140:141] neg_lo:[1,0,0] neg_hi:[1,0,0]
    v_pk_fma_f32 v[138:139], v[182:183], v[86:87], v[138:139]
    v_pk_fma_f32 v[142:143], v[178:179], v[86:87], v[142:143] neg_lo:[1,0,0] neg_hi:[1,0,0]
    v_cvt_pk_bf16_f32 v116, v136, v140
    v_cvt_pk_bf16_f32 v117, v137, v141
    v_cvt_pk_bf16_f32 v118, v138, v142
    v_cvt_pk_bf16_f32 v119, v139, v143
    v_pk_mul_f32 v[128:129], v[184:185], v[72:73]
    v_pk_mul_f32 v[132:133], v[188:189], v[72:73]
    v_pk_mul_f32 v[130:131], v[186:187], v[74:75]
    v_pk_mul_f32 v[134:135], v[190:191], v[74:75]
    v_mfma_f32_16x16x32_bf16 v[152:155], v[96:99], v[116:119], 0
    v_mfma_f32_16x16x32_bf16 v[156:159], v[100:103], v[116:119], 0
    v_pk_fma_f32 v[128:129], v[188:189], v[88:89], v[128:129]
    v_pk_fma_f32 v[132:133], v[184:185], v[88:89], v[132:133] neg_lo:[1,0,0] neg_hi:[1,0,0]
    v_pk_fma_f32 v[130:131], v[190:191], v[90:91], v[130:131]
    v_pk_fma_f32 v[134:135], v[186:187], v[90:91], v[134:135] neg_lo:[1,0,0] neg_hi:[1,0,0]
    v_cvt_pk_bf16_f32 v120, v128, v132
    v_cvt_pk_bf16_f32 v121, v129, v133
    v_cvt_pk_bf16_f32 v122, v130, v134
    v_cvt_pk_bf16_f32 v123, v131, v135
    v_pk_mul_f32 v[136:137], v[192:193], v[76:77]
    v_pk_mul_f32 v[140:141], v[196:197], v[76:77]
    v_pk_mul_f32 v[138:139], v[194:195], v[78:79]
    v_pk_mul_f32 v[142:143], v[198:199], v[78:79]
    v_mfma_f32_16x16x32_bf16 v[144:147], v[104:107], v[120:123], v[144:147]
    v_mfma_f32_16x16x32_bf16 v[148:151], v[108:111], v[120:123], v[148:151]
    v_mfma_f32_16x16x32_bf16 v[160:163], v[96:99], v[120:123], v[160:163]
    v_mfma_f32_16x16x32_bf16 v[164:167], v[100:103], v[120:123], v[164:167]
    v_pk_fma_f32 v[136:137], v[196:197], v[92:93], v[136:137]
    v_pk_fma_f32 v[140:141], v[192:193], v[92:93], v[140:141] neg_lo:[1,0,0] neg_hi:[1,0,0]
    v_pk_fma_f32 v[138:139], v[198:199], v[94:95], v[138:139]
    v_pk_fma_f32 v[142:143], v[194:195], v[94:95], v[142:143] neg_lo:[1,0,0] neg_hi:[1,0,0]
    v_cvt_pk_bf16_f32 v124, v136, v140
    v_cvt_pk_bf16_f32 v125, v137, v141
    v_cvt_pk_bf16_f32 v126, v138, v142
    v_cvt_pk_bf16_f32 v127, v139, v143
    s_nop 1
    v_mfma_f32_16x16x32_bf16 v[152:155], v[104:107], v[124:127], v[152:155]
    v_mfma_f32_16x16x32_bf16 v[156:159], v[108:111], v[124:127], v[156:159]
    v_lshrrev_b32 v14, 5, v0
    v_lshlrev_b32 v11, 16, v3
    v_lshl_add_u32 v11, v2, 2, v11
    v_and_b32 v12, 6, v2
    v_xor_b32 v12, v12, v3
    v_lshlrev_b32 v12, 4, v12
    v_lshl_add_u32 v4, v2, 7, v12
    v_add_u32 v4, 65536, v4
    v_xor_b32 v5, 64, v4
    v_bfe_u32 v12, v0, 2, 3
    v_bfe_u32 v13, v0, 1, 1
    v_and_b32 v15, 6, v12
    v_xor_b32 v13, v13, v15
    v_lshlrev_b32 v13, 4, v13
    v_lshl_add_u32 v13, v12, 7, v13
    v_and_b32 v15, 1, v0
    v_lshl_add_u32 v13, v15, 3, v13
    s_lshl_b32 s22, s3, 5
    v_xor_b32 v13, s22, v13
    v_lshl_add_u32 v6, v14, 12, v13
    v_lshl_add_u32 v8, v14, 11, v13
    s_and_b32 s60, s2, 15
    s_lshl_b32 s60, s60, 4
    s_bfe_u32 s61, s2, 0x20004
    s_lshl2_add_u32 s60, s61, s60
    s_lshr_b32 s61, s2, 6
    s_add_u32 s60, s60, s61
    s_lshl_b32 s60, s60, 6
    s_lshl_b32 s61, s3, 19
    s_add_u32 s61, s61, s60
    s_add_u32 s60, s60, 2097152
    v_lshlrev_b32 v241, 2, v2
    v_lshl_add_u32 v13, v14, 5, v241
    v_cvt_pk_bf16_f32 v200, v144, v148
    v_cvt_pk_bf16_f32 v201, v145, v149
    v_cvt_pk_bf16_f32 v202, v146, v150
    v_cvt_pk_bf16_f32 v203, v147, v151
    v_cvt_pk_bf16_f32 v204, v152, v156
    v_cvt_pk_bf16_f32 v205, v153, v157
    v_cvt_pk_bf16_f32 v206, v154, v158
    v_cvt_pk_bf16_f32 v207, v155, v159
    v_cvt_pk_bf16_f32 v215, v160, v164
    v_and_b32 v200, -2, v200
    v_and_b32 v201, -2, v201
    v_and_b32 v202, -2, v202
    v_and_b32 v203, -2, v203
    v_and_b32 v204, -2, v204
    v_and_b32 v205, -2, v205
    v_and_b32 v206, -2, v206
    v_and_b32 v207, -2, v207
    v_and_b32 v215, -2, v215
    s_mov_b32 s17, 16842752
    s_lshl_b32 s22, s3, 3
    s_lshr_b32 s17, s17, s22
    s_and_b32 s17, s17, 255
    s_cmp_eq_u32 s17, 0
    s_cbranch_scc0 C_TN0
    s_mov_b32 s17, 99
    s_call_b64 s[70:71], C_TST
C_TN0:
    s_mov_b32 s68, 1
    s_barrier
    ds_read_b64_tr_b16 v[48:49], v6 offset:0
    ds_read_b64_tr_b16 v[50:51], v6 offset:2048
    ds_read_b128 v[16:19], v4 offset:0
    ds_read_b128 v[20:23], v4 offset:2048
    ds_read_b128 v[24:27], v4 offset:4096
    ds_read_b128 v[28:31], v4 offset:6144
    ds_read_b64_tr_b16 v[52:53], v6 offset:1024
    ds_read_b64_tr_b16 v[54:55], v6 offset:3072
    ds_read_b64_tr_b16 v[56:57], v6 offset:8192
    ds_read_b64_tr_b16 v[58:59], v6 offset:10240
    ds_read_b128 v[32:35], v5 offset:0
    ds_read_b128 v[36:39], v5 offset:2048
    ds_read_b128 v[40:43], v5 offset:4096
    ds_read_b128 v[44:47], v5 offset:6144
    s_waitcnt lgkmcnt(8)
    ds_read_b64_tr_b16 v[60:61], v6 offset:9216
    ds_read_b64_tr_b16 v[62:63], v6 offset:11264
    v_pk_mul_f32 v[144:145], v[254:255], 0
    v_pk_mul_f32 v[146:147], v[254:255], 0
    v_pk_mul_f32 v[148:149], v[254:255], 0
    v_pk_mul_f32 v[150:151], v[254:255], 0
    v_pk_mul_f32 v[152:153], v[254:255], 0
    v_pk_mul_f32 v[154:155], v[254:255], 0
    v_pk_mul_f32 v[156:157], v[254:255], 0
    v_pk_mul_f32 v[158:159], v[254:255], 0
    v_pk_mul_f32 v[160:161], v[254:255], 0
    v_pk_mul_f32 v[162:163], v[254:255], 0
    v_pk_mul_f32 v[164:165], v[254:255], 0
    v_pk_mul_f32 v[166:167], v[254:255], 0
    v_pk_mul_f32 v[168:169], v[254:255], 0
    v_pk_mul_f32 v[170:171], v[254:255], 0
    v_pk_mul_f32 v[172:173], v[254:255], 0
    v_pk_mul_f32 v[174:175], v[254:255], 0
    v_lshlrev_b32 v9, 8, v14
    v_lshl_add_u32 v9, v2, 4, v9
    s_lshl2_add_u32 s53, s51, s3
    s_lshl_b32 s63, s53, 5
    s_add_u32 s63, s63, s50
    s_lshl_b32 s64, s63, 6
    s_add_u32 s64, s64, 7602176
    s_lshl_b32 s63, s63, 9
    s_add_u32 s63, s63, 7077888
    s_mov_b32 s22, 0x3f803f80
    v_mov_b32 v232, s22
    v_mov_b32 v233, s22
    v_mov_b32 v234, s22
    v_mov_b32 v235, s22
    s_mov_b32 s66, 0x3fb8aa3b
    s_mov_b32 s67, s66
    s_mov_b32 s65, 0x358637bd
    s_waitcnt lgkmcnt(0)
C_LOOP:
    s_barrier
    v_mfma_f32_16x16x32_bf16 v[144:147], v[16:19], v[48:51], v[144:147]
    ds_read_b64_tr_b16 v[96:97], v6 offset:16384
    ds_read_b64_tr_b16 v[98:99], v6 offset:18432
    v_mfma_f32_16x16x32_bf16 v[148:151], v[20:23], v[48:51], v[148:151]
    ds_read_b128 v[64:67], v4 offset:8192
    ds_read_b128 v[68:71], v4 offset:10240
    v_mfma_f32_16x16x32_bf16 v[152:155], v[24:27], v[48:51], v[152:155]
    ds_read_b128 v[72:75], v4 offset:12288
    ds_read_b128 v[76:79], v4 offset:14336
    v_mfma_f32_16x16x32_bf16 v[156:159], v[28:31], v[48:51], v[156:159]
    ds_read_b64_tr_b16 v[100:101], v6 offset:17408
    ds_read_b64_tr_b16 v[102:103], v6 offset:19456
    v_mfma_f32_16x16x32_bf16 v[160:163], v[16:19], v[52:55], v[160:163]
    ds_read_b64_tr_b16 v[104:105], v6 offset:24576
    ds_read_b64_tr_b16 v[106:107], v6 offset:26624
    v_mfma_f32_16x16x32_bf16 v[164:167], v[20:23], v[52:55], v[164:167]
    ds_read_b128 v[80:83], v5 offset:8192
    ds_read_b128 v[84:87], v5 offset:10240
    v_mfma_f32_16x16x32_bf16 v[168:171], v[24:27], v[52:55], v[168:171]
    ds_read_b128 v[88:91], v5 offset:12288
    ds_read_b128 v[92:95], v5 offset:14336
    v_mfma_f32_16x16x32_bf16 v[172:175], v[28:31], v[52:55], v[172:175]
    s_waitcnt lgkmcnt(8)
    ds_read_b64_tr_b16 v[108:109], v6 offset:25600
    ds_read_b64_tr_b16 v[110:111], v6 offset:27648
    v_mfma_f32_16x16x32_bf16 v[144:147], v[32:35], v[56:59], v[144:147]
    v_mfma_f32_16x16x32_bf16 v[148:151], v[36:39], v[56:59], v[148:151]
    v_mfma_f32_16x16x32_bf16 v[152:155], v[40:43], v[56:59], v[152:155]
    v_mfma_f32_16x16x32_bf16 v[156:159], v[44:47], v[56:59], v[156:159]
    v_add_u32 v4, 0x4000, v4
    v_add_u32 v5, 0x4000, v5
    v_xor_b32 v6, 0x8000, v6
    v_mfma_f32_16x16x32_bf16 v[160:163], v[32:35], v[60:63], v[160:163]
    v_mfma_f32_16x16x32_bf16 v[164:167], v[36:39], v[60:63], v[164:167]
    v_mfma_f32_16x16x32_bf16 v[168:171], v[40:43], v[60:63], v[168:171]
    v_mfma_f32_16x16x32_bf16 v[172:175], v[44:47], v[60:63], v[172:175]
    s_waitcnt lgkmcnt(0)
    s_cmp_eq_u32 s17, 1
    s_cbranch_scc0 C_TN1
    s_mov_b32 s17, 99
    s_call_b64 s[70:71], C_TST
C_TN1:
    s_cmp_lg_u32 s68, 3
    s_cbranch_scc1 C_NOW
    s_waitcnt vmcnt(0)
C_NOW:
    s_barrier
    v_mfma_f32_16x16x32_bf16 v[144:147], v[64:67], v[96:99], v[144:147]
    ds_read_b64_tr_b16 v[48:49], v6 offset:0
    ds_read_b64_tr_b16 v[50:51], v6 offset:2048
    v_mfma_f32_16x16x32_bf16 v[148:151], v[68:71], v[96:99], v[148:151]
    ds_read_b128 v[16:19], v4 offset:0
    ds_read_b128 v[20:23], v4 offset:2048
    v_mfma_f32_16x16x32_bf16 v[152:155], v[72:75], v[96:99], v[152:155]
    ds_read_b128 v[24:27], v4 offset:4096
    ds_read_b128 v[28:31], v4 offset:6144
    v_mfma_f32_16x16x32_bf16 v[156:159], v[76:79], v[96:99], v[156:159]
    ds_read_b64_tr_b16 v[52:53], v6 offset:1024
    ds_read_b64_tr_b16 v[54:55], v6 offset:3072
    v_mfma_f32_16x16x32_bf16 v[160:163], v[64:67], v[100:103], v[160:163]
    ds_read_b64_tr_b16 v[56:57], v6 offset:8192
    ds_read_b64_tr_b16 v[58:59], v6 offset:10240
    v_mfma_f32_16x16x32_bf16 v[164:167], v[68:71], v[100:103], v[164:167]
    ds_read_b128 v[32:35], v5 offset:0
    ds_read_b128 v[36:39], v5 offset:2048
    v_mfma_f32_16x16x32_bf16 v[168:171], v[72:75], v[100:103], v[168:171]
    ds_read_b128 v[40:43], v5 offset:4096
    ds_read_b128 v[44:47], v5 offset:6144
    v_mfma_f32_16x16x32_bf16 v[172:175], v[76:79], v[100:103], v[172:175]
    s_waitcnt lgkmcnt(8)
    ds_read_b64_tr_b16 v[60:61], v6 offset:9216
    ds_read_b64_tr_b16 v[62:63], v6 offset:11264
    v_mfma_f32_16x16x32_bf16 v[144:147], v[80:83], v[104:107], v[144:147]
    v_mfma_f32_16x16x32_bf16 v[148:151], v[84:87], v[104:107], v[148:151]
    v_mfma_f32_16x16x32_bf16 v[152:155], v[88:91], v[104:107], v[152:155]
    v_mfma_f32_16x16x32_bf16 v[156:159], v[92:95], v[104:107], v[156:159]
    s_add_u32 s68, s68, 2
    v_mfma_f32_16x16x32_bf16 v[160:163], v[80:83], v[108:111], v[160:163]
    v_mfma_f32_16x16x32_bf16 v[164:167], v[84:87], v[108:111], v[164:167]
    v_mfma_f32_16x16x32_bf16 v[168:171], v[88:91], v[108:111], v[168:171]
    v_mfma_f32_16x16x32_bf16 v[172:175], v[92:95], v[108:111], v[172:175]
    s_waitcnt lgkmcnt(0)
    s_cmp_lt_u32 s68, 7
    s_cbranch_scc1 C_LOOP
    v_mfma_f32_16x16x32_bf16 v[144:147], v[16:19], v[48:51], v[144:147]
    v_mfma_f32_16x16x32_bf16 v[148:151], v[20:23], v[48:51], v[148:151]
    v_mfma_f32_16x16x32_bf16 v[152:155], v[24:27], v[48:51], v[152:155]
    v_mfma_f32_16x16x32_bf16 v[156:159], v[28:31], v[48:51], v[156:159]
    s_barrier
    ds_read_b64_tr_b16 v[96:97], v6 offset:16384
    ds_read_b64_tr_b16 v[98:99], v6 offset:18432
    v_mfma_f32_16x16x32_bf16 v[144:147], v[32:35], v[56:59], v[144:147]
    ds_read_b128 v[64:67], v4 offset:8192
    ds_read_b128 v[68:71], v4 offset:10240
    v_mfma_f32_16x16x32_bf16 v[148:151], v[36:39], v[56:59], v[148:151]
    ds_read_b128 v[72:75], v4 offset:12288
    ds_read_b128 v[76:79], v4 offset:14336
    v_mfma_f32_16x16x32_bf16 v[152:155], v[40:43], v[56:59], v[152:155]
    ds_read_b64_tr_b16 v[104:105], v6 offset:24576
    ds_read_b64_tr_b16 v[106:107], v6 offset:26624
    v_mfma_f32_16x16x32_bf16 v[156:159], v[44:47], v[56:59], v[156:159]
    ds_read_b128 v[80:83], v5 offset:8192
    ds_read_b128 v[84:87], v5 offset:10240
    v_mfma_f32_16x16x32_bf16 v[160:163], v[16:19], v[52:55], v[160:163]
    ds_read_b128 v[88:91], v5 offset:12288
    ds_read_b128 v[92:95], v5 offset:14336
    v_mfma_f32_16x16x32_bf16 v[164:167], v[20:23], v[52:55], v[164:167]
    v_mfma_f32_16x16x32_bf16 v[168:171], v[24:27], v[52:55], v[168:171]
    v_mfma_f32_16x16x32_bf16 v[172:175], v[28:31], v[52:55], v[172:175]
    s_waitcnt lgkmcnt(9)
    v_mfma_f32_16x16x32_bf16 v[144:147], v[64:67], v[96:99], v[144:147]
    s_waitcnt lgkmcnt(8)
    v_mfma_f32_16x16x32_bf16 v[148:151], v[68:71], v[96:99], v[148:151]
    s_waitcnt lgkmcnt(7)
    v_mfma_f32_16x16x32_bf16 v[152:155], v[72:75], v[96:99], v[152:155]
    s_waitcnt lgkmcnt(6)
    v_mfma_f32_16x16x32_bf16 v[156:159], v[76:79], v[96:99], v[156:159]
    ds_read_b64_tr_b16 v[100:101], v6 offset:17408
    ds_read_b64_tr_b16 v[102:103], v6 offset:19456
    ds_read_b64_tr_b16 v[108:109], v6 offset:25600
    ds_read_b64_tr_b16 v[110:111], v6 offset:27648
    s_waitcnt lgkmcnt(7)
    v_mfma_f32_16x16x32_bf16 v[144:147], v[80:83], v[104:107], v[144:147]
    s_waitcnt lgkmcnt(6)
    v_mfma_f32_16x16x32_bf16 v[148:151], v[84:87], v[104:107], v[148:151]
    s_waitcnt lgkmcnt(5)
    v_mfma_f32_16x16x32_bf16 v[152:155], v[88:91], v[104:107], v[152:155]
    s_waitcnt lgkmcnt(4)
    v_mfma_f32_16x16x32_bf16 v[156:159], v[92:95], v[104:107], v[156:159]
    s_waitcnt lgkmcnt(0)
    s_mov_b64 exec, 1
    ds_add_u32 v254, v255 offset:56
    s_mov_b64 exec, -1
    v_mfma_f32_16x16x32_bf16 v[160:163], v[32:35], v[60:63], v[160:163]
    v_mfma_f32_16x16x32_bf16 v[164:167], v[36:39], v[60:63], v[164:167]
    v_pk_mul_f32 v[128:129], v[144:145], s[66:67]
    v_pk_mul_f32 v[130:131], v[146:147], s[66:67]
    v_mfma_f32_16x16x32_bf16 v[168:171], v[40:43], v[60:63], v[168:171]
    v_pk_mul_f32 v[132:133], v[148:149], s[66:67]
    v_pk_mul_f32 v[134:135], v[150:151], s[66:67]
    v_mfma_f32_16x16x32_bf16 v[172:175], v[44:47], v[60:63], v[172:175]
    v_pk_mul_f32 v[136:137], v[152:153], s[66:67]
    v_pk_mul_f32 v[138:139], v[154:155], s[66:67]
    v_mfma_f32_16x16x32_bf16 v[160:163], v[64:67], v[100:103], v[160:163]
    v_pk_mul_f32 v[140:141], v[156:157], s[66:67]
    v_pk_mul_f32 v[142:143], v[158:159], s[66:67]
    v_mfma_f32_16x16x32_bf16 v[164:167], v[68:71], v[100:103], v[164:167]
    v_exp_f32 v128, v128 clamp
    v_max_f32 v144, s65, v144
    v_mfma_f32_16x16x32_bf16 v[168:171], v[72:75], v[100:103], v[168:171]
    v_exp_f32 v129, v129 clamp
    v_max_f32 v145, s65, v145
    v_mfma_f32_16x16x32_bf16 v[172:175], v[76:79], v[100:103], v[172:175]
    v_exp_f32 v130, v130 clamp
    v_max_f32 v146, s65, v146
    v_mfma_f32_16x16x32_bf16 v[160:163], v[80:83], v[108:111], v[160:163]
    v_exp_f32 v131, v131 clamp
    v_max_f32 v147, s65, v147
    v_mfma_f32_16x16x32_bf16 v[164:167], v[84:87], v[108:111], v[164:167]
    v_exp_f32 v132, v132 clamp
    v_max_f32 v148, s65, v148
    v_mfma_f32_16x16x32_bf16 v[168:171], v[88:91], v[108:111], v[168:171]
    v_exp_f32 v133, v133 clamp
    v_max_f32 v149, s65, v149
    v_mfma_f32_16x16x32_bf16 v[172:175], v[92:95], v[108:111], v[172:175]
    v_exp_f32 v134, v134 clamp
    v_max_f32 v150, s65, v150
    v_exp_f32 v135, v135 clamp
    v_max_f32 v151, s65, v151
    v_exp_f32 v136, v136 clamp
    v_max_f32 v152, s65, v152
    v_exp_f32 v137, v137 clamp
    v_max_f32 v153, s65, v153
    v_exp_f32 v138, v138 clamp
    v_max_f32 v154, s65, v154
    v_exp_f32 v139, v139 clamp
    v_max_f32 v155, s65, v155
    v_exp_f32 v140, v140 clamp
    v_max_f32 v156, s65, v156
    v_exp_f32 v141, v141 clamp
    v_max_f32 v157, s65, v157
    v_exp_f32 v142, v142 clamp
    v_max_f32 v158, s65, v158
    v_exp_f32 v143, v143 clamp
    v_max_f32 v159, s65, v159
    v_cvt_pk_bf16_f32 v216, v160, v161
    v_cvt_pk_bf16_f32 v217, v162, v163
    v_cvt_pk_bf16_f32 v218, v164, v165
    v_cvt_pk_bf16_f32 v219, v166, v167
    v_cvt_pk_bf16_f32 v220, v168, v169
    v_cvt_pk_bf16_f32 v221, v170, v171
    v_cvt_pk_bf16_f32 v222, v172, v173
    v_cvt_pk_bf16_f32 v223, v174, v175
    v_pk_add_f32 v[144:145], v[144:145], v[128:129]
    v_pk_add_f32 v[146:147], v[146:147], v[130:131]
    v_pk_add_f32 v[148:149], v[148:149], v[132:133]
    v_pk_add_f32 v[150:151], v[150:151], v[134:135]
    v_pk_add_f32 v[152:153], v[152:153], v[136:137]
    v_pk_add_f32 v[154:155], v[154:155], v[138:139]
    v_pk_add_f32 v[156:157], v[156:157], v[140:141]
    v_pk_add_f32 v[158:159], v[158:159], v[142:143]
    v_cvt_pk_bf16_f32 v208, v144, v145
    v_cvt_pk_bf16_f32 v209, v146, v147
    v_cvt_pk_bf16_f32 v210, v148, v149
    v_cvt_pk_bf16_f32 v211, v150, v151
    v_cvt_pk_bf16_f32 v212, v152, v153
    v_cvt_pk_bf16_f32 v213, v154, v155
    v_mfma_f32_16x16x32_bf16 v[236:239], v[208:211], v[216:219], 0
    v_cvt_pk_bf16_f32 v214, v156, v157
    v_cvt_pk_bf16_f32 v215, v158, v159
    v_mfma_f32_16x16x32_bf16 v[244:247], v[232:235], v[208:211], 0
    s_nop 0
    v_mfma_f32_16x16x32_bf16 v[236:239], v[212:215], v[220:223], v[236:239]
    v_mfma_f32_16x16x32_bf16 v[244:247], v[232:235], v[212:215], v[244:247]
    v_subrev_u32 v4, 0xc000, v4
    v_subrev_u32 v5, 0xc000, v5
    s_nop 4
    v_cvt_pk_bf16_f32 v248, v236, v237
    v_cvt_pk_bf16_f32 v249, v238, v239
    v_min_u32 v250, -2, v248
    v_min_u32 v251, -2, v249
    v_min_u32 v248, -2, v248
    v_min_u32 v249, -2, v249
    v_min_u32 v244, -2, v244
    s_nop 0
    v_permlane16_swap_b32 v249, v251
    v_permlane16_swap_b32 v248, v250
    s_mov_b32 exec_lo, 0xffff
    s_mov_b32 exec_hi, 0xffff
    buffer_store_dwordx4 v[248:251], v9, s[24:27], s63 offen sc1
    s_mov_b32 exec_hi, 0
    buffer_store_dword v244, v241, s[24:27], s64 offen sc1
    s_mov_b64 exec, -1
    ds_read_b32 v253, v254 offset:32
    ds_read_b128 v[16:19], v4 offset:0
    ds_read_b128 v[20:23], v4 offset:2048
    ds_read_b128 v[24:27], v4 offset:4096
    ds_read_b128 v[28:31], v4 offset:6144
    ds_read_b128 v[32:35], v5 offset:0
    ds_read_b128 v[36:39], v5 offset:2048
    ds_read_b128 v[40:43], v5 offset:4096
    ds_read_b128 v[44:47], v5 offset:6144
    s_waitcnt lgkmcnt(8)
    v_cmp_ne_u32 vcc, 4, v253
    s_cbranch_vccnz C_QS0
C_QR0:
    ds_read_b64_tr_b16 v[128:129], v8 offset:0
    ds_read_b64_tr_b16 v[130:131], v8 offset:1024
    ds_read_b64_tr_b16 v[132:133], v8 offset:4096
    ds_read_b64_tr_b16 v[134:135], v8 offset:5120
    ds_read_b64_tr_b16 v[136:137], v8 offset:8192
    ds_read_b64_tr_b16 v[138:139], v8 offset:9216
    ds_read_b64_tr_b16 v[140:141], v8 offset:12288
    s_waitcnt lgkmcnt(10)
    ds_read_b64_tr_b16 v[142:143], v8 offset:13312
    ds_read_b32 v253, v254 offset:36
    s_waitcnt lgkmcnt(7)
    v_mfma_f32_16x16x32_bf16 v[112:115], v[128:131], v[16:19], 0
    ds_read_b128 v[48:51], v4 offset:8192
    ds_read_b128 v[52:55], v4 offset:10240
    v_mfma_f32_16x16x32_bf16 v[116:119], v[128:131], v[20:23], 0
    ds_read_b128 v[56:59], v4 offset:12288
    ds_read_b128 v[60:63], v4 offset:14336
    v_mfma_f32_16x16x32_bf16 v[120:123], v[128:131], v[24:27], 0
    ds_read_b128 v[64:67], v5 offset:8192
    ds_read_b128 v[68:71], v5 offset:10240
    v_mfma_f32_16x16x32_bf16 v[124:127], v[128:131], v[28:31], 0
    ds_read_b128 v[72:75], v5 offset:12288
    ds_read_b128 v[76:79], v5 offset:14336
    s_waitcnt lgkmcnt(8)
    v_cmp_ne_u32 vcc, 4, v253
    s_cbranch_vccnz C_QS1
C_QR1:
    v_mfma_f32_16x16x32_bf16 v[112:115], v[132:135], v[32:35], v[112:115]
    ds_read_b128 v[80:83], v4 offset:16384
    ds_read_b128 v[84:87], v4 offset:18432
    v_mfma_f32_16x16x32_bf16 v[116:119], v[132:135], v[36:39], v[116:119]
    ds_read_b128 v[88:91], v4 offset:20480
    ds_read_b128 v[92:95], v4 offset:22528
    v_mfma_f32_16x16x32_bf16 v[120:123], v[132:135], v[40:43], v[120:123]
    ds_read_b64_tr_b16 v[208:209], v8 offset:16384
    ds_read_b64_tr_b16 v[210:211], v8 offset:17408
    v_mfma_f32_16x16x32_bf16 v[124:127], v[132:135], v[44:47], v[124:127]
    ds_read_b64_tr_b16 v[212:213], v8 offset:20480
    s_waitcnt lgkmcnt(10)
    ds_read_b64_tr_b16 v[214:215], v8 offset:21504
    v_mfma_f32_16x16x32_bf16 v[112:115], v[136:139], v[48:51], v[112:115]
    ds_read_b64_tr_b16 v[216:217], v8 offset:24576
    ds_read_b64_tr_b16 v[218:219], v8 offset:25600
    v_mfma_f32_16x16x32_bf16 v[116:119], v[136:139], v[52:55], v[116:119]
    ds_read_b64_tr_b16 v[220:221], v8 offset:28672
    ds_read_b64_tr_b16 v[222:223], v8 offset:29696
    v_mfma_f32_16x16x32_bf16 v[120:123], v[136:139], v[56:59], v[120:123]
    s_waitcnt lgkmcnt(10)
    ds_read_b128 v[16:19], v5 offset:16384
    ds_read_b128 v[20:23], v5 offset:18432
    v_mfma_f32_16x16x32_bf16 v[124:127], v[136:139], v[60:63], v[124:127]
    ds_read_b128 v[24:27], v5 offset:20480
    ds_read_b128 v[28:31], v5 offset:22528
    v_mfma_f32_16x16x32_bf16 v[112:115], v[140:143], v[64:67], v[112:115]
    ds_read_b128 v[32:35], v4 offset:24576
    s_waitcnt lgkmcnt(10)
    ds_read_b128 v[36:39], v4 offset:26624
    v_mfma_f32_16x16x32_bf16 v[116:119], v[140:143], v[68:71], v[116:119]
    ds_read_b128 v[40:43], v4 offset:28672
    ds_read_b128 v[44:47], v4 offset:30720
    v_mfma_f32_16x16x32_bf16 v[120:123], v[140:143], v[72:75], v[120:123]
    ds_read_b128 v[48:51], v5 offset:24576
    ds_read_b128 v[52:55], v5 offset:26624
    v_mfma_f32_16x16x32_bf16 v[124:127], v[140:143], v[76:79], v[124:127]
    s_waitcnt lgkmcnt(10)
    ds_read_b128 v[56:59], v5 offset:28672
    ds_read_b128 v[60:63], v5 offset:30720
    ds_read_b32 v253, v254 offset:40
    s_mov_b64 exec, 1
    ds_add_u32 v254, v255 offset:64
    s_mov_b64 exec, -1
    v_mfma_f32_16x16x32_bf16 v[112:115], v[208:211], v[80:83], v[112:115]
    ds_read_b128 v[64:67], v4 offset:32768
    s_waitcnt lgkmcnt(10)
    ds_read_b128 v[68:71], v4 offset:34816
    v_mfma_f32_16x16x32_bf16 v[116:119], v[208:211], v[84:87], v[116:119]
    ds_read_b128 v[72:75], v4 offset:36864
    ds_read_b128 v[76:79], v4 offset:38912
    v_mfma_f32_16x16x32_bf16 v[120:123], v[208:211], v[88:91], v[120:123]
    v_mfma_f32_16x16x32_bf16 v[124:127], v[208:211], v[92:95], v[124:127]
    s_waitcnt lgkmcnt(5)
    v_cmp_ne_u32 vcc, 4, v253
    s_cbranch_vccnz C_QS2
C_QR2:
    v_mfma_f32_16x16x32_bf16 v[112:115], v[212:215], v[16:19], v[112:115]
    ds_read_b64_tr_b16 v[128:129], v8 offset:32768
    ds_read_b64_tr_b16 v[130:131], v8 offset:33792
    v_mfma_f32_16x16x32_bf16 v[116:119], v[212:215], v[20:23], v[116:119]
    ds_read_b64_tr_b16 v[132:133], v8 offset:36864
    ds_read_b64_tr_b16 v[134:135], v8 offset:37888
    v_mfma_f32_16x16x32_bf16 v[120:123], v[212:215], v[24:27], v[120:123]
    ds_read_b64_tr_b16 v[136:137], v8 offset:40960
    ds_read_b64_tr_b16 v[138:139], v8 offset:41984
    v_mfma_f32_16x16x32_bf16 v[124:127], v[212:215], v[28:31], v[124:127]
    ds_read_b64_tr_b16 v[140:141], v8 offset:45056
    ds_read_b64_tr_b16 v[142:143], v8 offset:46080
    v_mfma_f32_16x16x32_bf16 v[112:115], v[216:219], v[32:35], v[112:115]
    ds_read_b128 v[80:83], v5 offset:32768
    ds_read_b128 v[84:87], v5 offset:34816
    v_mfma_f32_16x16x32_bf16 v[116:119], v[216:219], v[36:39], v[116:119]
    s_waitcnt lgkmcnt(10)
    ds_read_b128 v[88:91], v5 offset:36864
    ds_read_b128 v[92:95], v5 offset:38912
    v_mfma_f32_16x16x32_bf16 v[120:123], v[216:219], v[40:43], v[120:123]
    ds_read_b128 v[16:19], v4 offset:40960
    ds_read_b128 v[20:23], v4 offset:43008
    v_mfma_f32_16x16x32_bf16 v[124:127], v[216:219], v[44:47], v[124:127]
    ds_read_b128 v[24:27], v4 offset:45056
    s_waitcnt lgkmcnt(10)
    ds_read_b128 v[28:31], v4 offset:47104
    v_mfma_f32_16x16x32_bf16 v[112:115], v[220:223], v[48:51], v[112:115]
    ds_read_b128 v[32:35], v5 offset:40960
    ds_read_b128 v[36:39], v5 offset:43008
    v_mfma_f32_16x16x32_bf16 v[116:119], v[220:223], v[52:55], v[116:119]
    ds_read_b128 v[40:43], v5 offset:45056
    ds_read_b128 v[44:47], v5 offset:47104
    v_mfma_f32_16x16x32_bf16 v[120:123], v[220:223], v[56:59], v[120:123]
    v_mfma_f32_16x16x32_bf16 v[124:127], v[220:223], v[60:63], v[124:127]
    s_waitcnt lgkmcnt(10)
    ds_read_b32 v253, v254 offset:44
    s_mov_b64 exec, 1
    ds_add_u32 v254, v255 offset:80
    s_mov_b64 exec, -1
    v_mfma_f32_16x16x32_bf16 v[112:115], v[128:131], v[64:67], v[112:115]
    ds_read_b128 v[48:51], v4 offset:49152
    ds_read_b128 v[52:55], v4 offset:51200
    v_mfma_f32_16x16x32_bf16 v[116:119], v[128:131], v[68:71], v[116:119]
    ds_read_b128 v[56:59], v4 offset:53248
    s_waitcnt lgkmcnt(10)
    ds_read_b128 v[60:63], v4 offset:55296
    v_mfma_f32_16x16x32_bf16 v[120:123], v[128:131], v[72:75], v[120:123]
    v_mfma_f32_16x16x32_bf16 v[124:127], v[128:131], v[76:79], v[124:127]
    s_waitcnt lgkmcnt(5)
    v_cmp_ne_u32 vcc, 4, v253
    s_cbranch_vccnz C_QS3
C_QR3:
    v_mfma_f32_16x16x32_bf16 v[112:115], v[132:135], v[80:83], v[112:115]
    ds_read_b64_tr_b16 v[208:209], v8 offset:49152
    ds_read_b64_tr_b16 v[210:211], v8 offset:50176
    v_mfma_f32_16x16x32_bf16 v[116:119], v[132:135], v[84:87], v[116:119]
    ds_read_b64_tr_b16 v[212:213], v8 offset:53248
    ds_read_b64_tr_b16 v[214:215], v8 offset:54272
    v_mfma_f32_16x16x32_bf16 v[120:123], v[132:135], v[88:91], v[120:123]
    ds_read_b64_tr_b16 v[216:217], v8 offset:57344
    ds_read_b64_tr_b16 v[218:219], v8 offset:58368
    v_mfma_f32_16x16x32_bf16 v[124:127], v[132:135], v[92:95], v[124:127]
    ds_read_b64_tr_b16 v[220:221], v8 offset:61440
    ds_read_b64_tr_b16 v[222:223], v8 offset:62464
    v_mfma_f32_16x16x32_bf16 v[112:115], v[136:139], v[16:19], v[112:115]
    ds_read_b128 v[64:67], v5 offset:49152
    ds_read_b128 v[68:71], v5 offset:51200
    v_mfma_f32_16x16x32_bf16 v[116:119], v[136:139], v[20:23], v[116:119]
    s_waitcnt lgkmcnt(10)
    ds_read_b128 v[72:75], v5 offset:53248
    ds_read_b128 v[76:79], v5 offset:55296
    v_mfma_f32_16x16x32_bf16 v[120:123], v[136:139], v[24:27], v[120:123]
    ds_read_b128 v[80:83], v4 offset:57344
    ds_read_b128 v[84:87], v4 offset:59392
    v_mfma_f32_16x16x32_bf16 v[124:127], v[136:139], v[28:31], v[124:127]
    ds_read_b128 v[88:91], v4 offset:61440
    s_waitcnt lgkmcnt(10)
    ds_read_b128 v[92:95], v4 offset:63488
    v_mfma_f32_16x16x32_bf16 v[112:115], v[140:143], v[32:35], v[112:115]
    ds_read_b128 v[16:19], v5 offset:57344
    ds_read_b128 v[20:23], v5 offset:59392
    v_mfma_f32_16x16x32_bf16 v[116:119], v[140:143], v[36:39], v[116:119]
    ds_read_b128 v[24:27], v5 offset:61440
    ds_read_b128 v[28:31], v5 offset:63488
    v_mfma_f32_16x16x32_bf16 v[120:123], v[140:143], v[40:43], v[120:123]
    v_mfma_f32_16x16x32_bf16 v[124:127], v[140:143], v[44:47], v[124:127]
    v_mfma_f32_16x16x32_bf16 v[112:115], v[208:211], v[48:51], v[112:115]
    v_mfma_f32_16x16x32_bf16 v[116:119], v[208:211], v[52:55], v[116:119]
    v_mfma_f32_16x16x32_bf16 v[120:123], v[208:211], v[56:59], v[120:123]
    v_mfma_f32_16x16x32_bf16 v[124:127], v[208:211], v[60:63], v[124:127]
    s_waitcnt lgkmcnt(8)
    v_mfma_f32_16x16x32_bf16 v[112:115], v[212:215], v[64:67], v[112:115]
    v_mfma_f32_16x16x32_bf16 v[116:119], v[212:215], v[68:71], v[116:119]
    v_mfma_f32_16x16x32_bf16 v[120:123], v[212:215], v[72:75], v[120:123]
    v_mfma_f32_16x16x32_bf16 v[124:127], v[212:215], v[76:79], v[124:127]
    s_waitcnt lgkmcnt(4)
    v_mfma_f32_16x16x32_bf16 v[112:115], v[216:219], v[80:83], v[112:115]
    v_mfma_f32_16x16x32_bf16 v[116:119], v[216:219], v[84:87], v[116:119]
    v_mfma_f32_16x16x32_bf16 v[120:123], v[216:219], v[88:91], v[120:123]
    v_mfma_f32_16x16x32_bf16 v[124:127], v[216:219], v[92:95], v[124:127]
    s_waitcnt lgkmcnt(0)
    v_mfma_f32_16x16x32_bf16 v[112:115], v[220:223], v[16:19], v[112:115]
    v_mfma_f32_16x16x32_bf16 v[116:119], v[220:223], v[20:23], v[116:119]
    v_mfma_f32_16x16x32_bf16 v[120:123], v[220:223], v[24:27], v[120:123]
    v_mfma_f32_16x16x32_bf16 v[124:127], v[220:223], v[28:31], v[124:127]
    s_mov_b64 exec, 1
    ds_add_u32 v254, v255 offset:4
    s_mov_b64 exec, -1
    s_mov_b64 s[36:37], s[8:9]
    s_mov_b32 s38, 0x80000
    s_mov_b32 s39, s31
    s_lshl_b32 s21, s3, 14
    s_lshl_b32 s22, s55, 7
    s_add_u32 s21, s21, s22
    v_lshrrev_b32 v242, 3, v0
    v_and_b32 v243, 7, v0
    v_and_b32 v230, 6, v242
    v_xor_b32 v243, v243, v230
    v_lshlrev_b32 v243, 4, v243
    v_and_b32 v230, 4, v242
    v_add_u32 v242, v242, v230
    v_lshl_add_u32 v242, v242, 10, v243
    v_lshlrev_b32 v243, 4, v3
    v_lshrrev_b32 v11, 2, v2
    v_lshl_add_u32 v11, v14, 2, v11
    v_lshlrev_b32 v11, 7, v11
    v_and_b32 v230, 3, v2
    v_lshl_add_u32 v11, v230, 4, v11
    v_and_b32 v230, 1, v3
    v_lshl_add_u32 v11, v230, 3, v11
    s_lshl_b32 s58, s53, 11
    s_add_u32 s58, s58, 7012352
    ds_read_b32 v1, v254 offset:60
    v_pk_mul_f32 v[128:129], v[112:113], s[66:67]
    v_pk_mul_f32 v[130:131], v[114:115], s[66:67]
    v_pk_mul_f32 v[132:133], v[116:117], s[66:67]
    v_pk_mul_f32 v[134:135], v[118:119], s[66:67]
    v_pk_mul_f32 v[136:137], v[120:121], s[66:67]
    v_pk_mul_f32 v[138:139], v[122:123], s[66:67]
    v_pk_mul_f32 v[140:141], v[124:125], s[66:67]
    v_pk_mul_f32 v[142:143], v[126:127], s[66:67]
    v_exp_f32 v128, v128 clamp
    v_max_f32 v112, s65, v112
    v_exp_f32 v129, v129 clamp
    v_max_f32 v113, s65, v113
    v_exp_f32 v130, v130 clamp
    v_max_f32 v114, s65, v114
    v_exp_f32 v131, v131 clamp
    v_max_f32 v115, s65, v115
    v_exp_f32 v132, v132 clamp
    v_max_f32 v116, s65, v116
    v_exp_f32 v133, v133 clamp
    v_max_f32 v117, s65, v117
    v_exp_f32 v134, v134 clamp
    v_max_f32 v118, s65, v118
    v_exp_f32 v135, v135 clamp
    v_max_f32 v119, s65, v119
    v_exp_f32 v136, v136 clamp
    v_max_f32 v120, s65, v120
    v_exp_f32 v137, v137 clamp
    v_max_f32 v121, s65, v121
    v_exp_f32 v138, v138 clamp
    v_max_f32 v122, s65, v122
    v_exp_f32 v139, v139 clamp
    v_max_f32 v123, s65, v123
    v_exp_f32 v140, v140 clamp
    v_max_f32 v124, s65, v124
    v_exp_f32 v141, v141 clamp
    v_max_f32 v125, s65, v125
    v_exp_f32 v142, v142 clamp
    v_max_f32 v126, s65, v126
    v_exp_f32 v143, v143 clamp
    v_max_f32 v127, s65, v127
    v_pk_add_f32 v[112:113], v[112:113], v[128:129]
    v_pk_add_f32 v[114:115], v[114:115], v[130:131]
    v_pk_add_f32 v[116:117], v[116:117], v[132:133]
    v_pk_add_f32 v[118:119], v[118:119], v[134:135]
    v_pk_add_f32 v[120:121], v[120:121], v[136:137]
    v_pk_add_f32 v[122:123], v[122:123], v[138:139]
    v_pk_add_f32 v[124:125], v[124:125], v[140:141]
    v_pk_add_f32 v[126:127], v[126:127], v[142:143]
    v_cvt_pk_bf16_f32 v96, v112, v113
    v_cvt_pk_bf16_f32 v97, v114, v115
    v_cvt_pk_bf16_f32 v98, v116, v117
    v_cvt_pk_bf16_f32 v99, v118, v119
    v_cvt_pk_bf16_f32 v100, v120, v121
    v_cvt_pk_bf16_f32 v101, v122, v123
    v_cvt_pk_bf16_f32 v102, v124, v125
    v_cvt_pk_bf16_f32 v103, v126, v127
C_XW:
    ds_read_b32 v253, v254 offset:4
    s_sub_u32 s74, s74, 1
    s_cbranch_scc1 L_END
    s_waitcnt lgkmcnt(0)
    v_cmp_ne_u32 vcc, 4, v253
    s_cbranch_vccnz C_XW
    v_readfirstlane_b32 s56, v1
    s_cmp_lt_u32 s56, 201
    s_cbranch_scc0 C_NORD
C_RDW:
    s_sleep 1
    ds_read_b32 v253, v254 offset:48
    s_sub_u32 s74, s74, 1
    s_cbranch_scc1 L_END
    s_waitcnt lgkmcnt(0)
    v_cmp_ne_u32 vcc, 4, v253
    s_cbranch_vccnz C_RDW
C_NORD:
    s_add_u32 s5, s57, 2
    s_and_b32 s5, s5, 7
    s_lshl_b32 s5, s5, 16
    s_add_u32 m0, s69, 81920
    s_add_u32 s5, s5, s21
    buffer_load_dwordx4 v242, s[36:39], s5 offen lds
    s_add_u32 s5, s5, 3072
    buffer_load_dwordx4 v242, s[36:39], s5 offen offset:1024 lds
    s_add_u32 s5, s57, 3
    s_and_b32 s5, s5, 7
    s_lshl_b32 s5, s5, 16
    s_add_u32 m0, s69, 90112
    s_add_u32 s5, s5, s21
    buffer_load_dwordx4 v242, s[36:39], s5 offen lds
    s_add_u32 s5, s5, 3072
    buffer_load_dwordx4 v242, s[36:39], s5 offen offset:1024 lds
    s_add_u32 s5, s57, 4
    s_and_b32 s5, s5, 7
    s_lshl_b32 s5, s5, 16
    s_add_u32 m0, s69, 98304
    s_add_u32 s5, s5, s21
    buffer_load_dwordx4 v242, s[36:39], s5 offen lds
    s_add_u32 s5, s5, 3072
    buffer_load_dwordx4 v242, s[36:39], s5 offen offset:1024 lds
    s_add_u32 s5, s57, 5
    s_and_b32 s5, s5, 7
    s_lshl_b32 s5, s5, 16
    s_add_u32 m0, s69, 106496
    s_add_u32 s5, s5, s21
    buffer_load_dwordx4 v242, s[36:39], s5 offen lds
    s_add_u32 s5, s5, 3072
    buffer_load_dwordx4 v242, s[36:39], s5 offen offset:1024 lds
    buffer_load_dwordx4 v[80:83], v243, s[24:27], s58 offen offset:1024 sc1
    buffer_load_dwordx2 v[86:87], v11, s[24:27], s58 offen sc1
    s_add_u32 s5, s57, 6
    s_and_b32 s5, s5, 7
    s_lshl_b32 s5, s5, 16
    s_add_u32 m0, s69, 114688
    s_add_u32 s5, s5, s21
    buffer_load_dwordx4 v242, s[36:39], s5 offen lds
    s_add_u32 s5, s5, 3072
    buffer_load_dwordx4 v242, s[36:39], s5 offen offset:1024 lds
    s_add_u32 s5, s57, 7
    s_and_b32 s5, s5, 7
    s_lshl_b32 s5, s5, 16
    s_add_u32 m0, s69, 122880
    s_add_u32 s5, s5, s21
    buffer_load_dwordx4 v242, s[36:39], s5 offen lds
    s_add_u32 s5, s5, 3072
    buffer_load_dwordx4 v242, s[36:39], s5 offen offset:1024 lds
    v_and_b32 v12, 1, v3
    v_lshl_add_u32 v12, v12, 14, v9
    s_lshl_b32 s61, s50, 16
    s_lshl_b32 s62, s53, 9
    s_add_u32 s61, s61, s62
    s_add_u32 s61, s61, 8388608
    s_add_u32 s62, s61, 0x8000
    s_lshl_b32 s6, s54, 7
    s_add_u32 s6, s6, 7671808
    s_lshl_b32 s7, s50, 5
    s_add_u32 s7, s7, s53
    s_lshl_b32 s7, s7, 2
    s_add_u32 s7, s7, 7671808
    ds_read_b64 v[238:239], v254 offset:24
    s_waitcnt vmcnt(4)
C_PF:
    v_max3_u32 v1, v80, v81, v82
    v_max3_u32 v14, v83, v86, v87
    v_cvt_pk_bf16_f32 v84, v80, v81
    v_max_u32 v1, v1, v14
    v_cvt_pk_bf16_f32 v85, v82, v83
    v_cmp_eq_u32 vcc, -1, v1
    s_cbranch_vccnz C_PFRE
    s_setprio 3
    v_mfma_f32_16x16x16_bf16 v[112:115], v[84:85], v[96:97], 0
    v_mfma_f32_16x16x16_bf16 v[116:119], v[84:85], v[98:99], 0
    v_mfma_f32_16x16x16_bf16 v[120:123], v[84:85], v[100:101], 0
    v_mfma_f32_16x16x16_bf16 v[124:127], v[84:85], v[102:103], 0
    v_mfma_f32_16x16x16_bf16 v[128:131], v[86:87], v[96:97], 0
    v_mfma_f32_16x16x16_bf16 v[132:135], v[86:87], v[98:99], 0
    v_mfma_f32_16x16x16_bf16 v[136:139], v[86:87], v[100:101], 0
    v_mfma_f32_16x16x16_bf16 v[140:143], v[86:87], v[102:103], 0
    s_waitcnt lgkmcnt(0)
    v_readfirstlane_b32 s75, v238
    v_readfirstlane_b32 s73, v239
    v_add_f32 v112, s65, v112
    v_add_f32 v116, s65, v116
    v_add_f32 v120, s65, v120
    v_add_f32 v124, s65, v124
    v_rcp_f32 v112, v112
    v_rcp_f32 v116, v116
    v_rcp_f32 v120, v120
    v_rcp_f32 v124, v124
    s_cmp_eq_u32 s73, 4
    s_cbranch_scc0 C_MW
C_MWR:
    s_nop 2
    v_pk_mul_f32 v[128:129], v[128:129], v[112:113] op_sel_hi:[1,0]
    v_pk_mul_f32 v[130:131], v[130:131], v[112:113] op_sel_hi:[1,0]
    v_cvt_pk_bf16_f32 v244, v128, v129
    v_cvt_pk_bf16_f32 v245, v130, v131
    v_pk_mul_f32 v[132:133], v[132:133], v[116:117] op_sel_hi:[1,0]
    v_pk_mul_f32 v[134:135], v[134:135], v[116:117] op_sel_hi:[1,0]
    v_cvt_pk_bf16_f32 v246, v132, v133
    v_cvt_pk_bf16_f32 v247, v134, v135
    s_nop 0
    v_permlane16_swap_b32 v244, v246
    v_permlane16_swap_b32 v245, v247
    v_pk_mul_f32 v[136:137], v[136:137], v[120:121] op_sel_hi:[1,0]
    v_pk_mul_f32 v[138:139], v[138:139], v[120:121] op_sel_hi:[1,0]
    v_cvt_pk_bf16_f32 v248, v136, v137
    v_cvt_pk_bf16_f32 v249, v138, v139
    v_pk_mul_f32 v[140:141], v[140:141], v[124:125] op_sel_hi:[1,0]
    v_pk_mul_f32 v[142:143], v[142:143], v[124:125] op_sel_hi:[1,0]
    v_cvt_pk_bf16_f32 v250, v140, v141
    v_cvt_pk_bf16_f32 v251, v142, v143
    s_nop 0
    v_permlane16_swap_b32 v248, v250
    v_permlane16_swap_b32 v249, v251
    s_cmp_eq_u32 s75, 0
    s_cbranch_scc0 C_OSLOW
    buffer_store_dwordx4 v[244:247], v12, s[24:27], s61 offen
    buffer_store_dwordx4 v[248:251], v12, s[24:27], s62 offen
C_OST:
    s_setprio 2
    s_lshl_b32 s22, s3, 5
    v_xor_b32 v8, s22, v8
    v_add_u32 v8, 81920, v8
    v_xor_b32 v9, 32, v8
    v_xor_b32 v10, 64, v8
    v_xor_b32 v11, 96, v8
    v_lshlrev_b32 v13, 2, v0
    s_lshl2_add_u32 s58, s54, s3
    s_lshl_b32 s61, s58, 15
    s_lshl_b32 s58, s58, 14
    s_add_u32 s58, s58, 8388608
    s_lshl_b32 s60, s57, 11
    s_add_u32 s60, s60, 4096
    s_lshl_b32 s22, s55, 7
    s_add_u32 s61, s61, s22
    v_lshlrev_b32 v12, 11, v2
    v_and_b32 v14, 1, v3
    v_lshl_add_u32 v12, v14, 5, v12
    v_lshrrev_b32 v14, 1, v3
    v_lshl_add_u32 v12, v14, 4, v12
    s_cmp_eq_u32 s75, 0
    s_waitcnt vmcnt(0)
    s_mov_b64 exec, 1
    s_cbranch_scc0 C_FSLOW
    buffer_store_dword v255, v7, s[24:27], s7 offen
C_FST:
    s_mov_b64 exec, -1
    s_mov_b64 exec, 1
    ds_add_u32 v254, v255 offset:8
    s_mov_b64 exec, -1
C_WW:
    ds_read_b32 v253, v254 offset:8
    s_sub_u32 s74, s74, 1
    s_cbranch_scc1 L_END
    s_waitcnt lgkmcnt(0)
    v_cmp_ne_u32 vcc, 4, v253
    s_cbranch_vccnz C_WW
C_WW2:
    ds_read_b32 v253, v254 offset:76
    s_sub_u32 s74, s74, 1
    s_cbranch_scc1 L_END
    s_waitcnt lgkmcnt(0)
    v_cmp_ne_u32 vcc, 4, v253
    s_cbranch_vccnz C_WW2
    ds_read_b64_tr_b16 v[80:81], v8 offset:0
    ds_read_b64_tr_b16 v[82:83], v8 offset:1024
    ds_read_b64_tr_b16 v[84:85], v9 offset:0
    ds_read_b64_tr_b16 v[86:87], v9 offset:1024
    ds_read_b64_tr_b16 v[88:89], v10 offset:0
    ds_read_b64_tr_b16 v[90:91], v10 offset:1024
    ds_read_b64_tr_b16 v[92:93], v11 offset:0
    ds_read_b64_tr_b16 v[94:95], v11 offset:1024
    ds_read_b64_tr_b16 v[96:97], v8 offset:4096
    ds_read_b64_tr_b16 v[98:99], v8 offset:5120
    ds_read_b64_tr_b16 v[100:101], v9 offset:4096
    ds_read_b64_tr_b16 v[102:103], v9 offset:5120
    ds_read_b64_tr_b16 v[104:105], v10 offset:4096
    ds_read_b64_tr_b16 v[106:107], v10 offset:5120
    ds_read_b64_tr_b16 v[108:109], v11 offset:4096
    s_waitcnt lgkmcnt(10)
    ds_read_b64_tr_b16 v[110:111], v11 offset:5120
    ds_read_b64_tr_b16 v[112:113], v8 offset:8192
    ds_read_b64_tr_b16 v[114:115], v8 offset:9216
    ds_read_b64_tr_b16 v[116:117], v9 offset:8192
    ds_read_b64_tr_b16 v[118:119], v9 offset:9216
    s_waitcnt lgkmcnt(10)
    ds_read_b64_tr_b16 v[120:121], v10 offset:8192
    ds_read_b64_tr_b16 v[122:123], v10 offset:9216
    ds_read_b64_tr_b16 v[124:125], v11 offset:8192
    ds_read_b64_tr_b16 v[126:127], v11 offset:9216
    ds_read_b64_tr_b16 v[160:161], v8 offset:12288
    s_waitcnt lgkmcnt(10)
    ds_read_b64_tr_b16 v[162:163], v8 offset:13312
    ds_read_b64_tr_b16 v[164:165], v9 offset:12288
    ds_read_b64_tr_b16 v[166:167], v9 offset:13312
    ds_read_b64_tr_b16 v[168:169], v10 offset:12288
    ds_read_b64_tr_b16 v[170:171], v10 offset:13312
    s_waitcnt lgkmcnt(10)
    ds_read_b64_tr_b16 v[172:173], v11 offset:12288
    ds_read_b64_tr_b16 v[174:175], v11 offset:13312
    s_mov_b32 exec_hi, 0
    buffer_load_dword v1, v13, s[24:27], s6 offen sc1
    s_mov_b32 exec_hi, -1
    ds_read_b64_tr_b16 v[176:177], v8 offset:16384
    ds_read_b64_tr_b16 v[178:179], v8 offset:17408
    ds_read_b64_tr_b16 v[180:181], v9 offset:16384
    s_waitcnt lgkmcnt(10)
    ds_read_b64_tr_b16 v[182:183], v9 offset:17408
    ds_read_b64_tr_b16 v[184:185], v10 offset:16384
    ds_read_b64_tr_b16 v[186:187], v10 offset:17408
    ds_read_b64_tr_b16 v[188:189], v11 offset:16384
    ds_read_b64_tr_b16 v[190:191], v11 offset:17408
    s_waitcnt lgkmcnt(10)
    ds_read_b64_tr_b16 v[192:193], v8 offset:20480
    ds_read_b64_tr_b16 v[194:195], v8 offset:21504
    ds_read_b64_tr_b16 v[196:197], v9 offset:20480
    ds_read_b64_tr_b16 v[198:199], v9 offset:21504
    ds_read_b64_tr_b16 v[200:201], v10 offset:20480
    s_waitcnt lgkmcnt(10)
    ds_read_b64_tr_b16 v[202:203], v10 offset:21504
    ds_read_b64_tr_b16 v[204:205], v11 offset:20480
    ds_read_b64_tr_b16 v[206:207], v11 offset:21504
    ds_read_b64_tr_b16 v[208:209], v8 offset:24576
    ds_read_b64_tr_b16 v[210:211], v8 offset:25600
    s_waitcnt lgkmcnt(10)
    ds_read_b64_tr_b16 v[212:213], v9 offset:24576
    ds_read_b64_tr_b16 v[214:215], v9 offset:25600
    ds_read_b64_tr_b16 v[216:217], v10 offset:24576
    ds_read_b64_tr_b16 v[218:219], v10 offset:25600
    ds_read_b64_tr_b16 v[220:221], v11 offset:24576
    s_waitcnt lgkmcnt(10)
    ds_read_b64_tr_b16 v[222:223], v11 offset:25600
    ds_read_b64_tr_b16 v[224:225], v8 offset:28672
    ds_read_b64_tr_b16 v[226:227], v8 offset:29696
    ds_read_b64_tr_b16 v[228:229], v9 offset:28672
    ds_read_b64_tr_b16 v[230:231], v9 offset:29696
    s_waitcnt lgkmcnt(10)
    ds_read_b64_tr_b16 v[232:233], v10 offset:28672
    ds_read_b64_tr_b16 v[234:235], v10 offset:29696
    ds_read_b64_tr_b16 v[236:237], v11 offset:28672
    ds_read_b64_tr_b16 v[238:239], v11 offset:29696
    ds_read_b64_tr_b16 v[144:145], v8 offset:32768
    s_waitcnt lgkmcnt(10)
    ds_read_b64_tr_b16 v[146:147], v8 offset:33792
    ds_read_b64_tr_b16 v[148:149], v9 offset:32768
    ds_read_b64_tr_b16 v[150:151], v9 offset:33792
    ds_read_b64_tr_b16 v[152:153], v10 offset:32768
    ds_read_b64_tr_b16 v[154:155], v10 offset:33792
    s_waitcnt lgkmcnt(10)
    ds_read_b64_tr_b16 v[156:157], v11 offset:32768
    ds_read_b64_tr_b16 v[158:159], v11 offset:33792
    s_mov_b32 exec_hi, 0
C_OP:
    s_waitcnt vmcnt(0)
    v_cmp_ne_u32 vcc, 1, v1
    s_cbranch_vccnz C_OPRE
    s_mov_b64 exec, -1
    s_add_u32 s22, s60, 0
    s_and_b32 s22, s22, 0x3fff
    s_add_u32 s22, s22, s58
    buffer_load_dwordx4 v[16:19], v7, s[24:27], s22 offen offset:0 sc1
    buffer_load_dwordx4 v[20:23], v7, s[24:27], s22 offen offset:1024 sc1
    s_add_u32 s22, s60, 2048
    s_and_b32 s22, s22, 0x3fff
    s_add_u32 s22, s22, s58
    buffer_load_dwordx4 v[24:27], v7, s[24:27], s22 offen offset:0 sc1
    buffer_load_dwordx4 v[28:31], v7, s[24:27], s22 offen offset:1024 sc1
    s_add_u32 s22, s60, 4096
    s_and_b32 s22, s22, 0x3fff
    s_add_u32 s22, s22, s58
    buffer_load_dwordx4 v[32:35], v7, s[24:27], s22 offen offset:0 sc1
    buffer_load_dwordx4 v[36:39], v7, s[24:27], s22 offen offset:1024 sc1
    s_add_u32 s22, s60, 6144
    s_and_b32 s22, s22, 0x3fff
    s_add_u32 s22, s22, s58
    buffer_load_dwordx4 v[40:43], v7, s[24:27], s22 offen offset:0 sc1
    buffer_load_dwordx4 v[44:47], v7, s[24:27], s22 offen offset:1024 sc1
    s_add_u32 s22, s60, 8192
    s_and_b32 s22, s22, 0x3fff
    s_add_u32 s22, s22, s58
    buffer_load_dwordx4 v[48:51], v7, s[24:27], s22 offen offset:0 sc1
    buffer_load_dwordx4 v[52:55], v7, s[24:27], s22 offen offset:1024 sc1
    s_waitcnt vmcnt(9)
    v_mfma_f32_16x16x32_bf16 v[128:131], v[80:83], v[16:19], 0
    v_mfma_f32_16x16x32_bf16 v[132:135], v[84:87], v[16:19], 0
    v_mfma_f32_16x16x32_bf16 v[136:139], v[88:91], v[16:19], 0
    v_mfma_f32_16x16x32_bf16 v[140:143], v[92:95], v[16:19], 0
    s_add_u32 s22, s60, 10240
    s_and_b32 s22, s22, 0x3fff
    s_add_u32 s22, s22, s58
    buffer_load_dwordx4 v[56:59], v7, s[24:27], s22 offen offset:0 sc1
    buffer_load_dwordx4 v[60:63], v7, s[24:27], s22 offen offset:1024 sc1
    s_waitcnt vmcnt(10)
    v_mfma_f32_16x16x32_bf16 v[128:131], v[96:99], v[20:23], v[128:131]
    ds_read_b64_tr_b16 v[80:81], v8 offset:36864
    ds_read_b64_tr_b16 v[82:83], v8 offset:37888
    v_mfma_f32_16x16x32_bf16 v[132:135], v[100:103], v[20:23], v[132:135]
    ds_read_b64_tr_b16 v[84:85], v9 offset:36864
    s_waitcnt lgkmcnt(10)
    ds_read_b64_tr_b16 v[86:87], v9 offset:37888
    v_mfma_f32_16x16x32_bf16 v[136:139], v[104:107], v[20:23], v[136:139]
    ds_read_b64_tr_b16 v[88:89], v10 offset:36864
    ds_read_b64_tr_b16 v[90:91], v10 offset:37888
    v_mfma_f32_16x16x32_bf16 v[140:143], v[108:111], v[20:23], v[140:143]
    ds_read_b64_tr_b16 v[92:93], v11 offset:36864
    ds_read_b64_tr_b16 v[94:95], v11 offset:37888
    s_add_u32 s22, s60, 12288
    s_and_b32 s22, s22, 0x3fff
    s_add_u32 s22, s22, s58
    buffer_load_dwordx4 v[64:67], v7, s[24:27], s22 offen offset:0 sc1
    buffer_load_dwordx4 v[68:71], v7, s[24:27], s22 offen offset:1024 sc1
    s_waitcnt vmcnt(11)
    v_mfma_f32_16x16x32_bf16 v[128:131], v[112:115], v[24:27], v[128:131]
    s_waitcnt lgkmcnt(10)
    ds_read_b64_tr_b16 v[96:97], v8 offset:40960
    ds_read_b64_tr_b16 v[98:99], v8 offset:41984
    v_mfma_f32_16x16x32_bf16 v[132:135], v[116:119], v[24:27], v[132:135]
    ds_read_b64_tr_b16 v[100:101], v9 offset:40960
    ds_read_b64_tr_b16 v[102:103], v9 offset:41984
    v_mfma_f32_16x16x32_bf16 v[136:139], v[120:123], v[24:27], v[136:139]
    ds_read_b64_tr_b16 v[104:105], v10 offset:40960
    s_waitcnt lgkmcnt(10)
    ds_read_b64_tr_b16 v[106:107], v10 offset:41984
    v_mfma_f32_16x16x32_bf16 v[140:143], v[124:127], v[24:27], v[140:143]
    ds_read_b64_tr_b16 v[108:109], v11 offset:40960
    ds_read_b64_tr_b16 v[110:111], v11 offset:41984
    s_add_u32 s22, s60, 14336
    s_and_b32 s22, s22, 0x3fff
    s_add_u32 s22, s22, s58
    buffer_load_dwordx4 v[72:75], v7, s[24:27], s22 offen offset:0 sc1
    buffer_load_dwordx4 v[76:79], v7, s[24:27], s22 offen offset:1024 sc1
    s_mov_b64 exec, 1
    ds_add_u32 v254, v255 offset:52
    s_mov_b64 exec, -1
    s_waitcnt vmcnt(12)
    v_mfma_f32_16x16x32_bf16 v[128:131], v[160:163], v[28:31], v[128:131]
    ds_read_b64_tr_b16 v[112:113], v8 offset:45056
    s_waitcnt lgkmcnt(10)
    ds_read_b64_tr_b16 v[114:115], v8 offset:46080
    v_mfma_f32_16x16x32_bf16 v[132:135], v[164:167], v[28:31], v[132:135]
    ds_read_b64_tr_b16 v[116:117], v9 offset:45056
    ds_read_b64_tr_b16 v[118:119], v9 offset:46080
    v_mfma_f32_16x16x32_bf16 v[136:139], v[168:171], v[28:31], v[136:139]
    ds_read_b64_tr_b16 v[120:121], v10 offset:45056
    ds_read_b64_tr_b16 v[122:123], v10 offset:46080
    v_mfma_f32_16x16x32_bf16 v[140:143], v[172:175], v[28:31], v[140:143]
    s_waitcnt lgkmcnt(10)
    ds_read_b64_tr_b16 v[124:125], v11 offset:45056
    ds_read_b64_tr_b16 v[126:127], v11 offset:46080
    s_waitcnt vmcnt(11)
    v_mfma_f32_16x16x32_bf16 v[128:131], v[176:179], v[32:35], v[128:131]
    ds_read_b64_tr_b16 v[160:161], v8 offset:49152
    ds_read_b64_tr_b16 v[162:163], v8 offset:50176
    v_mfma_f32_16x16x32_bf16 v[132:135], v[180:183], v[32:35], v[132:135]
    ds_read_b64_tr_b16 v[164:165], v9 offset:49152
    s_waitcnt lgkmcnt(10)
    ds_read_b64_tr_b16 v[166:167], v9 offset:50176
    v_mfma_f32_16x16x32_bf16 v[136:139], v[184:187], v[32:35], v[136:139]
    ds_read_b64_tr_b16 v[168:169], v10 offset:49152
    ds_read_b64_tr_b16 v[170:171], v10 offset:50176
    v_mfma_f32_16x16x32_bf16 v[140:143], v[188:191], v[32:35], v[140:143]
    ds_read_b64_tr_b16 v[172:173], v11 offset:49152
    ds_read_b64_tr_b16 v[174:175], v11 offset:50176
    s_waitcnt vmcnt(10)
    v_mfma_f32_16x16x32_bf16 v[128:131], v[192:195], v[36:39], v[128:131]
    s_waitcnt lgkmcnt(10)
    ds_read_b64_tr_b16 v[176:177], v8 offset:53248
    ds_read_b64_tr_b16 v[178:179], v8 offset:54272
    v_mfma_f32_16x16x32_bf16 v[132:135], v[196:199], v[36:39], v[132:135]
    ds_read_b64_tr_b16 v[180:181], v9 offset:53248
    ds_read_b64_tr_b16 v[182:183], v9 offset:54272
    v_mfma_f32_16x16x32_bf16 v[136:139], v[200:203], v[36:39], v[136:139]
    ds_read_b64_tr_b16 v[184:185], v10 offset:53248
    s_waitcnt lgkmcnt(10)
    ds_read_b64_tr_b16 v[186:187], v10 offset:54272
    v_mfma_f32_16x16x32_bf16 v[140:143], v[204:207], v[36:39], v[140:143]
    ds_read_b64_tr_b16 v[188:189], v11 offset:53248
    ds_read_b64_tr_b16 v[190:191], v11 offset:54272
    s_waitcnt vmcnt(9)
    v_mfma_f32_16x16x32_bf16 v[128:131], v[208:211], v[40:43], v[128:131]
    ds_read_b64_tr_b16 v[192:193], v8 offset:57344
    ds_read_b64_tr_b16 v[194:195], v8 offset:58368
    v_mfma_f32_16x16x32_bf16 v[132:135], v[212:215], v[40:43], v[132:135]
    s_waitcnt lgkmcnt(10)
    ds_read_b64_tr_b16 v[196:197], v9 offset:57344
    ds_read_b64_tr_b16 v[198:199], v9 offset:58368
    v_mfma_f32_16x16x32_bf16 v[136:139], v[216:219], v[40:43], v[136:139]
    ds_read_b64_tr_b16 v[200:201], v10 offset:57344
    ds_read_b64_tr_b16 v[202:203], v10 offset:58368
    v_mfma_f32_16x16x32_bf16 v[140:143], v[220:223], v[40:43], v[140:143]
    ds_read_b64_tr_b16 v[204:205], v11 offset:57344
    s_waitcnt lgkmcnt(10)
    ds_read_b64_tr_b16 v[206:207], v11 offset:58368
    s_waitcnt vmcnt(8)
    v_mfma_f32_16x16x32_bf16 v[128:131], v[224:227], v[44:47], v[128:131]
    ds_read_b64_tr_b16 v[208:209], v8 offset:61440
    ds_read_b64_tr_b16 v[210:211], v8 offset:62464
    v_mfma_f32_16x16x32_bf16 v[132:135], v[228:231], v[44:47], v[132:135]
    ds_read_b64_tr_b16 v[212:213], v9 offset:61440
    ds_read_b64_tr_b16 v[214:215], v9 offset:62464
    v_mfma_f32_16x16x32_bf16 v[136:139], v[232:235], v[44:47], v[136:139]
    s_waitcnt lgkmcnt(10)
    ds_read_b64_tr_b16 v[216:217], v10 offset:61440
    ds_read_b64_tr_b16 v[218:219], v10 offset:62464
    v_mfma_f32_16x16x32_bf16 v[140:143], v[236:239], v[44:47], v[140:143]
    ds_read_b64_tr_b16 v[220:221], v11 offset:61440
    ds_read_b64_tr_b16 v[222:223], v11 offset:62464
    s_waitcnt vmcnt(7)
    v_mfma_f32_16x16x32_bf16 v[128:131], v[144:147], v[48:51], v[128:131]
    v_mfma_f32_16x16x32_bf16 v[132:135], v[148:151], v[48:51], v[132:135]
    v_mfma_f32_16x16x32_bf16 v[136:139], v[152:155], v[48:51], v[136:139]
    v_mfma_f32_16x16x32_bf16 v[140:143], v[156:159], v[48:51], v[140:143]
    s_waitcnt vmcnt(6)
    v_mfma_f32_16x16x32_bf16 v[128:131], v[80:83], v[52:55], v[128:131]
    v_mfma_f32_16x16x32_bf16 v[132:135], v[84:87], v[52:55], v[132:135]
    v_mfma_f32_16x16x32_bf16 v[136:139], v[88:91], v[52:55], v[136:139]
    v_mfma_f32_16x16x32_bf16 v[140:143], v[92:95], v[52:55], v[140:143]
    s_waitcnt vmcnt(5)
    v_mfma_f32_16x16x32_bf16 v[128:131], v[96:99], v[56:59], v[128:131]
    v_mfma_f32_16x16x32_bf16 v[132:135], v[100:103], v[56:59], v[132:135]
    v_mfma_f32_16x16x32_bf16 v[136:139], v[104:107], v[56:59], v[136:139]
    v_mfma_f32_16x16x32_bf16 v[140:143], v[108:111], v[56:59], v[140:143]
    s_waitcnt vmcnt(4)
    v_mfma_f32_16x16x32_bf16 v[128:131], v[112:115], v[60:63], v[128:131]
    v_mfma_f32_16x16x32_bf16 v[132:135], v[116:119], v[60:63], v[132:135]
    v_mfma_f32_16x16x32_bf16 v[136:139], v[120:123], v[60:63], v[136:139]
    v_mfma_f32_16x16x32_bf16 v[140:143], v[124:127], v[60:63], v[140:143]
    s_waitcnt vmcnt(3)
    v_mfma_f32_16x16x32_bf16 v[128:131], v[160:163], v[64:67], v[128:131]
    v_mfma_f32_16x16x32_bf16 v[132:135], v[164:167], v[64:67], v[132:135]
    v_mfma_f32_16x16x32_bf16 v[136:139], v[168:171], v[64:67], v[136:139]
    v_mfma_f32_16x16x32_bf16 v[140:143], v[172:175], v[64:67], v[140:143]
    s_waitcnt vmcnt(2)
    v_mfma_f32_16x16x32_bf16 v[128:131], v[176:179], v[68:71], v[128:131]
    v_mfma_f32_16x16x32_bf16 v[132:135], v[180:183], v[68:71], v[132:135]
    v_mfma_f32_16x16x32_bf16 v[136:139], v[184:187], v[68:71], v[136:139]
    v_mfma_f32_16x16x32_bf16 v[140:143], v[188:191], v[68:71], v[140:143]
    s_waitcnt vmcnt(1)
    s_waitcnt lgkmcnt(8)
    v_mfma_f32_16x16x32_bf16 v[128:131], v[192:195], v[72:75], v[128:131]
    v_mfma_f32_16x16x32_bf16 v[132:135], v[196:199], v[72:75], v[132:135]
    v_mfma_f32_16x16x32_bf16 v[136:139], v[200:203], v[72:75], v[136:139]
    v_mfma_f32_16x16x32_bf16 v[140:143], v[204:207], v[72:75], v[140:143]
    s_waitcnt vmcnt(0)
    s_waitcnt lgkmcnt(0)
    v_mfma_f32_16x16x32_bf16 v[128:131], v[208:211], v[76:79], v[128:131]
    v_mfma_f32_16x16x32_bf16 v[132:135], v[212:215], v[76:79], v[132:135]
    v_mfma_f32_16x16x32_bf16 v[136:139], v[216:219], v[76:79], v[136:139]
    v_mfma_f32_16x16x32_bf16 v[140:143], v[220:223], v[76:79], v[140:143]
    s_nop 4
    v_cvt_pk_bf16_f32 v144, v128, v129
    v_cvt_pk_bf16_f32 v145, v130, v131
    v_cvt_pk_bf16_f32 v146, v132, v133
    v_cvt_pk_bf16_f32 v147, v134, v135
    s_nop 0
    v_permlane16_swap_b32 v144, v146
    v_permlane16_swap_b32 v145, v147
    buffer_store_dwordx4 v[144:147], v12, s[40:43], s61 offen offset:0
    v_cvt_pk_bf16_f32 v148, v136, v137
    v_cvt_pk_bf16_f32 v149, v138, v139
    v_cvt_pk_bf16_f32 v150, v140, v141
    v_cvt_pk_bf16_f32 v151, v142, v143
    s_nop 0
    v_permlane16_swap_b32 v148, v150
    v_permlane16_swap_b32 v149, v151
    buffer_store_dwordx4 v[148:151], v12, s[40:43], s61 offen offset:64
    s_endpgm
C_TST:
    buffer_store_dword v200, v11, s[24:27], s61 offen sc1
    s_add_u32 s61, s61, 16384
    buffer_store_dword v201, v11, s[24:27], s61 offen sc1
    s_add_u32 s61, s61, 16384
    buffer_store_dword v202, v11, s[24:27], s61 offen sc1
    s_add_u32 s61, s61, 16384
    buffer_store_dword v203, v11, s[24:27], s61 offen sc1
    s_add_u32 s61, s61, 212992
    buffer_store_dword v204, v11, s[24:27], s61 offen sc1
    s_add_u32 s61, s61, 16384
    buffer_store_dword v205, v11, s[24:27], s61 offen sc1
    s_add_u32 s61, s61, 16384
    buffer_store_dword v206, v11, s[24:27], s61 offen sc1
    s_add_u32 s61, s61, 16384
    buffer_store_dword v207, v11, s[24:27], s61 offen sc1
    s_add_u32 s61, s61, 16384
    s_cmp_eq_u32 s3, 0
    s_cbranch_scc0 C_TRET2
    s_mov_b32 exec_lo, 0xff
    s_mov_b32 exec_hi, 0xff
    buffer_store_dword v215, v13, s[24:27], s60 offen sc1
    s_mov_b64 exec, -1
C_TRET2:
    s_setpc_b64 s[70:71]
C_OPRE:
    s_sub_u32 s72, s72, 1
    s_cbranch_scc1 L_END
    buffer_load_dword v1, v13, s[24:27], s6 offen sc1
    s_branch C_OP
C_QS0:
    ds_read_b32 v253, v254 offset:32
    s_sub_u32 s74, s74, 1
    s_cbranch_scc1 L_END
    s_waitcnt lgkmcnt(0)
    v_cmp_ne_u32 vcc, 4, v253
    s_cbranch_vccnz C_QS0
    s_branch C_QR0
C_QS1:
    ds_read_b32 v253, v254 offset:36
    s_sub_u32 s74, s74, 1
    s_cbranch_scc1 L_END
    s_waitcnt lgkmcnt(0)
    v_cmp_ne_u32 vcc, 4, v253
    s_cbranch_vccnz C_QS1
    s_branch C_QR1
C_QS2:
    ds_read_b32 v253, v254 offset:40
    s_sub_u32 s74, s74, 1
    s_cbranch_scc1 L_END
    s_waitcnt lgkmcnt(0)
    v_cmp_ne_u32 vcc, 4, v253
    s_cbranch_vccnz C_QS2
    s_branch C_QR2
C_QS3:
    ds_read_b32 v253, v254 offset:44
    s_sub_u32 s74, s74, 1
    s_cbranch_scc1 L_END
    s_waitcnt lgkmcnt(0)
    v_cmp_ne_u32 vcc, 4, v253
    s_cbranch_vccnz C_QS3
    s_branch C_QR3
L_REDRE:
    s_sub_u32 s72, s72, 1
    s_cbranch_scc1 L_END
    s_sleep 2
    s_branch L_RED
L_URE:
    s_sub_u32 s72, s72, 1
    s_cbranch_scc1 L_END
    s_sleep 4
    s_waitcnt lgkmcnt(0)
    s_branch L_UL
L_H1REB:
    s_sub_u32 s72, s72, 1
    s_cbranch_scc1 L_END
    s_sleep 2
    buffer_load_dword v205, v250, s[24:27], 0 offen sc1
    s_waitcnt vmcnt(0)
    s_branch L_H1B
L_H1REN:
    s_sub_u32 s72, s72, 1
    s_cbranch_scc1 L_END
    s_sleep 2
    buffer_load_dword v205, v250, s[24:27], 0 offen sc1
    s_waitcnt vmcnt(0)
    s_branch L_H1N
C_PFRE:
    s_sub_u32 s72, s72, 1
    s_cbranch_scc1 L_END
    s_sleep 2
    buffer_load_dwordx4 v[80:83], v243, s[24:27], s58 offen offset:1024 sc1
    buffer_load_dwordx2 v[86:87], v11, s[24:27], s58 offen sc1
    s_waitcnt vmcnt(0)
    s_branch C_PF
C_MW:
    ds_read_b32 v253, v254 offset:28
    s_sub_u32 s74, s74, 1
    s_cbranch_scc1 L_END
    s_waitcnt lgkmcnt(0)
    v_cmp_ne_u32 vcc, 4, v253
    s_cbranch_vccnz C_MW
    ds_read_b32 v238, v254 offset:24
    s_waitcnt lgkmcnt(0)
    v_readfirstlane_b32 s75, v238
    s_branch C_MWR
C_OSLOW:
    buffer_store_dwordx4 v[244:247], v12, s[24:27], s61 offen sc1
    buffer_store_dwordx4 v[248:251], v12, s[24:27], s62 offen sc1
    s_branch C_OST
C_FSLOW:
    buffer_store_dword v255, v7, s[24:27], s7 offen sc1
    s_branch C_FST
L_GORE:
    s_sub_u32 s72, s72, 1
    s_cbranch_scc1 L_END
    s_sleep 2
    buffer_load_dword v204, v249, s[44:47], 0 offen sc1
    s_waitcnt vmcnt(0)
    s_branch L_GO
L_END:
    s_endpgm
.fill (33280-(.-concat_heads__linear_attn_block__spectral_gfnet__prompt_kernel))/4, 4, 0xbf810000
.section .rodata,"a"
.p2align 6
.amdhsa_kernel concat_heads__linear_attn_block__spectral_gfnet__prompt_kernel
  .amdhsa_next_free_vgpr 256
  .amdhsa_next_free_sgpr 102
  .amdhsa_accum_offset 256
  .amdhsa_group_segment_fixed_size 0
  .amdhsa_kernarg_size 72
  .amdhsa_user_sgpr_count 2
  .amdhsa_user_sgpr_kernarg_segment_ptr 1
  .amdhsa_system_sgpr_workgroup_id_x 1
.end_amdhsa_kernel
```
